```python
import torch

def _softmax(x, axis=-1):
    return torch.softmax(x, dim=axis)
def _gelu(x):
    return torch.nn.functional.gelu(x, approximate="tanh")
def _silu(x):
    return torch.nn.functional.silu(x)
def _sigmoid(x):
    return torch.sigmoid(x)
def _layernorm(x, axis=-1, eps=1e-5):
    m = x.mean(dim=axis, keepdim=True)
    v = x.var(dim=axis, keepdim=True, unbiased=False)
    return (x - m) / torch.sqrt(v + eps)
def _scatter_add(tgt, idx, src, axis=0):
    return tgt.clone().index_add_(axis, idx, src)
def _segment_sum(src, seg, n):
    out = torch.zeros((n,) + src.shape[1:], dtype=src.dtype)
    return out.index_add_(0, seg, src)
def _pad(x, pw):
    flat = tuple(v for pair in reversed(pw) for v in pair)
    return torch.nn.functional.pad(x, flat)

kernel_name = 'recurrent_scan__grouped_kv_mqa__moe_arch_mod__prompt'

def setup_inputs():

    _w = (lambda a: (lambda t: t.to(torch.bfloat16) if t.is_floating_point() else t)(torch.as_tensor(a)))
    def _A_setup():
        B, S, D, H = 1, 2048, 1024, 32
        Dh = D // H
        return {
            "x": _w((lambda *s: torch.randn(*s, dtype=torch.bfloat16) * 0.05)(B, S, D)),
            "wq": _w((lambda *s: torch.randn(*s, dtype=torch.bfloat16) * 0.05)(D, H * Dh)),
            "wk": _w((lambda *s: torch.randn(*s, dtype=torch.bfloat16) * 0.05)(D, Dh)),
            "wv": _w((lambda *s: torch.randn(*s, dtype=torch.bfloat16) * 0.05)(D, Dh)),
            "wo": _w((lambda *s: torch.randn(*s, dtype=torch.bfloat16) * 0.05)(H * Dh, D)),
        }
    _A_in = _A_setup()

    def _B_setup():
        B, S, D, F, C = 1, 2048, 1024, 3584, 1
        return {
            "x": _w((lambda *s: torch.randn(*s, dtype=torch.bfloat16) * 0.05)(B, S, D)),
            "w_r": _w((lambda *s: torch.randn(*s, dtype=torch.bfloat16) * 0.05)(D)),
            "w_gate": _w((lambda *s: torch.randn(*s, dtype=torch.bfloat16) * 0.05)(D, F)),
            "w_up": _w((lambda *s: torch.randn(*s, dtype=torch.bfloat16) * 0.05)(D, F)),
            "w_down": _w((lambda *s: torch.randn(*s, dtype=torch.bfloat16) * 0.05)(F, D)),
        }
    _B_in = _B_setup()

    return {
        "A_x": _A_in["x"],
        "A_wq": _A_in["wq"],
        "A_wk": _A_in["wk"],
        "A_wv": _A_in["wv"],
        "A_wo": _A_in["wo"],
        "B_x": _B_in["x"],
        "B_w_r": _B_in["w_r"],
        "B_w_gate": _B_in["w_gate"],
        "B_w_up": _B_in["w_up"],
        "B_w_down": _B_in["w_down"],
    }

def reference(A_x, A_wq, A_wk, A_wv, A_wo, B_x, B_w_r, B_w_gate, B_w_up, B_w_down):
    def _A_ref(x, wq, wk, wv, wo):
        B, S, D = x.shape
        H = 32
        Dh = D // H
        q = (lambda x, *d: x.permute(*d))((x @ wq).reshape(B, S, H, Dh), 0, 2, 1, 3)
        k = x @ wk
        v = x @ wv
        scores = torch.einsum("bhqd,bkd->bhqk", q, k) * (Dh ** -0.5)
        p = _softmax(scores, axis=-1)
        o = torch.einsum("bhqk,bkd->bhqd", p, v)
        return (lambda x, *d: x.permute(*d))(o, 0, 2, 1, 3).reshape(B, S, H * Dh) @ wo

    def _B_ref(x, w_r, w_gate, w_up, w_down):
        B, S, D = x.shape
        C = 1
        r = x @ w_r
        idx = torch.argsort(-r, axis=-1)[:, :C]
        idx_e = (lambda x, n, axis: torch.repeat_interleave(x, n, dim=axis))(idx.reshape(B, C, 1), D, axis=2)
        x_sel = (lambda x, i, axis: torch.take_along_dim(x, i, dim=axis))(x, idx_e, axis=1)
        g = _silu(x_sel @ w_gate)
        u = x_sel @ w_up
        y = (g * u) @ w_down
        r_sel = _sigmoid((lambda x, i, axis: torch.take_along_dim(x, i, dim=axis))(r, idx, axis=1))
        y = y * r_sel.reshape(B, C, 1)
        b_off = (torch.arange(B) * S).reshape(B, 1)
        flat_idx = (idx + b_off).reshape(B * C)
        zero = (x * 0.0).reshape(B * S, D)
        upd = _scatter_add(zero, flat_idx, y.reshape(B * C, D), axis=0)
        return x + upd.reshape(B, S, D)

    x = A_x
    xn = _layernorm(x, axis=-1)
    s = _A_ref(xn, A_wq, A_wk, A_wv, A_wo)
    g = _silu(_B_ref(xn, B_w_r, B_w_gate, B_w_up, B_w_down))
    return x + s * g
```

```asm
; @launch grid=(256,1,1) block=(512,1,1) lds=163840
.amdgcn_target "amdgcn-amd-amdhsa--gfx950"
.text
.set CODE_BYTES, L_code_end - recurrent_scan__grouped_kv_mqa__moe_arch_mod__prompt_kernel - 64
.globl recurrent_scan__grouped_kv_mqa__moe_arch_mod__prompt_kernel
.p2align 8
.type recurrent_scan__grouped_kv_mqa__moe_arch_mod__prompt_kernel,@function
recurrent_scan__grouped_kv_mqa__moe_arch_mod__prompt_kernel:
    s_cmp_ge_u32 s2, 256
    s_cbranch_scc1 L_end
    s_load_dwordx16 s[68:83], s[0:1], 0
    s_load_dwordx8 s[84:91], s[0:1], 64
    s_load_dwordx2 s[92:93], s[0:1], 96
    s_getpc_b64 s[94:95]
    v_lshrrev_b32 v1, 6, v0
    v_and_b32 v2, 63, v0
    v_readfirstlane_b32 s3, v1
    s_and_b32 s4, s2, 0xf8
    s_mul_i32 s4, s4, 160
    v_lshlrev_b32 v8, 7, v0
    v_cmp_gt_u32 vcc, 10, v0
    v_add_u32 v8, s4, v8
    v_min_u32 v8, CODE_BYTES, v8
    s_and_saveexec_b64 s[64:65], vcc
    s_cbranch_execz L_1
    global_load_dword v47, v8, s[94:95]
L_1:
    s_mov_b64 exec, s[64:65]
    v_lshlrev_b32 v20, 4, v2
    v_and_b32 v3, 31, v2
    v_lshrrev_b32 v4, 5, v2
    s_and_b32 s39, s2, 7
    s_lshr_b32 s40, s2, 3
    s_lshr_b32 s36, s39, 1
    s_lshl_b32 s36, s36, 3
    s_and_b32 s53, s39, 1
    s_lshl_b32 s41, s53, 2
    s_add_u32 s57, s36, s41
    s_and_b32 s42, s40, 3
    s_add_u32 s57, s57, s42
    s_lshr_b32 s58, s40, 2
    s_and_b32 s38, s40, 7
    s_add_u32 s36, s36, s38
    s_lshr_b32 s42, s40, 3
    s_add_u32 s37, s41, s42
    s_lshl_b32 s52, s36, 2
    s_add_u32 s52, s52, s42
    s_mul_i32 s56, s39, 28
    s_add_u32 s56, s56, s40
    s_lshl_b32 s43, s3, 10
    s_lshl_b32 s45, s3, 12
    s_lshl_b32 s63, s3, 13
    s_and_b32 s49, s3, 1
    s_lshr_b32 s50, s3, 1
    s_lshl_b32 s51, s36, 1
    s_add_u32 s51, s51, s49
    s_lshl_b32 s60, s36, 17
    s_lshl_b32 s59, s37, 8
    s_sub_u32 s66, s3, 5
    s_cmp_lt_u32 s3, 4
    s_cselect_b32 s44, s53, 2
    v_lshrrev_b32 v5, 4, v2
    s_lshl_b32 s39, s3, 2
    v_add_u32 v6, s39, v5
    v_xor_b32 v7, v6, v2
    v_and_b32 v7, 7, v7
    v_lshlrev_b32 v7, 4, v7
    v_lshrrev_b32 v8, 3, v2
    v_lshl_add_u32 v7, v8, 11, v7
    s_lshl_b32 s39, s3, 14
    v_add_u32 v18, s39, v7
    v_lshrrev_b32 v7, 2, v2
    v_lshlrev_b32 v7, 11, v7
    v_and_b32 v8, 3, v2
    v_lshl_add_u32 v7, v8, 4, v7
    s_lshl_b32 s39, s49, 16
    s_lshl_b32 s40, s50, 6
    s_add_u32 s39, s39, s40
    v_add_u32 v19, s39, v7
    v_lshlrev_b32 v7, 2, v2
    v_mov_b32 v9, 0
    v_mov_b32 v17, 0
    v_mov_b32 v16, 1
    s_xor_b32 s61, s3, 7
    s_lshl_b32 s61, s61, 8
    s_add_u32 s61, s61, s2
    v_and_b32 v1, 28, v7
    s_waitcnt lgkmcnt(0)
    s_mov_b32 s4, s68
    s_and_b32 s5, s69, 0xffff
    s_mov_b32 s6, 0x400000
    s_mov_b32 s7, 0x20000
    s_cmp_eq_u32 s53, 0
    s_cselect_b32 s12, s72, s74
    s_cselect_b32 s13, s73, s75
    s_and_b32 s13, s13, 0xffff
    s_mov_b32 s14, 0x10000
    s_mov_b32 s15, 0x20000
    s_mov_b32 s16, s92
    s_and_b32 s17, s93, 0xffff
    s_mov_b32 s18, 0x500000
    s_mov_b32 s19, 0x20000
    s_mov_b32 s24, s80
    s_and_b32 s25, s81, 0xffff
    s_mov_b32 s26, 0x800
    s_mov_b32 s27, 0x20000
    s_cmp_lt_u32 s61, 8
    s_cbranch_scc0 L_2
    v_mov_b32 v10, 0
    v_mov_b32 v11, 0
    v_mov_b32 v8, 0
    s_lshl_b32 s41, s2, 12
    s_add_u32 s41, s41, 0x60000
    buffer_store_dwordx4 v[8:11], v20, s[16:19], s41 offen offset:0 sc1
    buffer_store_dwordx4 v[8:11], v20, s[16:19], s41 offen offset:1024 sc1
    buffer_store_dwordx4 v[8:11], v20, s[16:19], s41 offen offset:2048 sc1
    buffer_store_dwordx4 v[8:11], v20, s[16:19], s41 offen offset:3072 sc1
    s_lshl_b32 s41, s2, 2
    s_waitcnt vmcnt(0)
    v_mov_b32 v10, s41
    global_store_dword v10, v16, s[90:91] sc1
L_2:
    s_mov_b32 s8, s70
    s_and_b32 s9, s71, 0xffff
    s_mov_b32 s10, 0x200000
    s_mov_b32 s11, 0x20000
    v_lshlrev_b32 v8, 7, v3
    s_lshl_b32 s39, s52, 15
    s_add_u32 s39, s39, s45
    buffer_load_dword v47, v8, s[4:7], s39 offen
    s_lshl_b32 s40, s3, 8
    s_add_u32 m0, s40, 155648
    s_add_u32 s47, s38, s3
    s_and_b32 s47, s47, 7
    s_lshl_b32 s47, s47, 8
    buffer_load_dword v7, s[24:27], s47 offen lds
    s_add_u32 m0, s43, 147456
    s_add_u32 s47, s38, 0
    s_and_b32 s47, s47, 7
    s_lshl_b32 s47, s47, 13
    s_add_u32 s47, s47, s43
    buffer_load_dwordx4 v20, s[12:15], s47 offen lds
    s_add_u32 m0, s43, 139264
    s_add_u32 s47, s38, 0
    s_and_b32 s47, s47, 7
    s_lshl_b32 s47, s47, 8
    s_add_u32 s47, s47, s60
    buffer_load_dwordx4 v18, s[4:7], s47 offen lds
    s_add_u32 m0, s43, 131072
    s_add_u32 s47, s38, 0
    s_and_b32 s47, s47, 7
    s_lshl_b32 s47, s47, 8
    s_add_u32 s47, s47, s60
    s_add_u32 s47, s47, 128
    buffer_load_dwordx4 v18, s[4:7], s47 offen lds
    s_mov_b32 s20, s92
    s_and_b32 s21, s93, 0xffff
    s_mov_b32 s22, 0x40000
    s_mov_b32 s23, 0x20000
    s_mov_b32 s28, s82
    s_and_b32 s29, s83, 0xffff
    s_mov_b32 s30, 0x700000
    s_mov_b32 s31, 0x20000
    s_mov_b32 s32, s84
    s_and_b32 s33, s85, 0xffff
    s_mov_b32 s34, 0x700000
    s_mov_b32 s35, 0x20000
    v_mov_b32 v8, 0x3f803f80
    v_add_u32 v9, 157696, v7
    ds_write_b32 v9, v8
    ds_write_b32 v9, v17 offset:384
    v_bfe_u32 v5, v3, 1, 3
    v_xor_b32 v5, v5, v4
    s_lshl_b32 s39, s49, 12
    s_lshl_b32 s40, s49, 2
    v_lshlrev_b32 v6, 7, v3
    v_add_u32 v8, s39, v6
    v_xor_b32 v9, s40, v5
    v_lshl_add_u32 v32, v9, 4, v8
    v_xor_b32 v33, 32, v32
    v_xor_b32 v34, 0x1000, v32
    v_xor_b32 v35, 0x1020, v32
    v_add_u32 v36, 0x10000, v32
    v_add_u32 v40, 0x20000, v32
    v_add_u32 v37, 0x10000, v33
    v_add_u32 v41, 0x20000, v33
    v_add_u32 v38, 0x10000, v34
    v_add_u32 v42, 0x20000, v34
    v_add_u32 v39, 0x10000, v35
    v_add_u32 v43, 0x20000, v35
    s_and_b32 s39, s37, 3
    s_lshl_b32 s39, s39, 11
    v_add_u32 v8, s39, v6
    s_lshl_b32 s40, s49, 2
    v_xor_b32 v9, s40, v5
    v_lshl_add_u32 v96, v9, 4, v8
    v_xor_b32 v9, 2, v9
    v_lshl_add_u32 v97, v9, 4, v8
    s_and_b32 s41, s3, 3
    s_lshl_b32 s42, s41, 6
    s_add_u32 s42, s42, 155648
    v_lshlrev_b32 v8, 4, v4
    v_add_u32 v8, s42, v8
    v_mov_b32 v9, 157696
    v_cmp_eq_u32 vcc, 17, v3
    v_mov_b32 v10, 256
    s_nop 0
    v_cndmask_b32 v8, v9, v8, vcc
    v_cndmask_b32 v99, 0, v10, vcc
    v_add_u32 v9, 32, v8
    v_cmp_gt_u32 vcc, 16, v3
    s_nop 1
    v_cndmask_b32 v98, 0, 1, vcc
    v_cndmask_b32 v96, v8, v96, vcc
    v_cndmask_b32 v97, v9, v97, vcc
    v_bfe_u32 v5, v2, 2, 2
    v_lshl_add_u32 v6, v4, 3, v5
    v_bfe_u32 v8, v2, 4, 1
    v_lshlrev_b32 v8, 5, v8
    v_and_b32 v9, 3, v2
    v_lshl_add_u32 v8, v9, 3, v8
    v_lshl_add_u32 v9, v6, 6, v8
    s_lshl_b32 s42, s41, 11
    v_add_u32 v103, s42, v9
    v_add_u32 v44, s43, v9
    v_add_u32 v45, 0x10000, v44
    v_add_u32 v46, 0x20000, v44
    v_bfe_u32 v5, v2, 2, 1
    v_cmp_eq_u32 vcc, 0, v5
    v_mov_b32 v6, 0x3f803f80
    s_nop 0
    v_cndmask_b32 v24, 0, v6, vcc
    v_cndmask_b32 v25, 0, v6, vcc
    v_cndmask_b32 v26, v6, 0, vcc
    v_cndmask_b32 v27, v6, 0, vcc
    v_and_b32 v5, 2, v2
    v_cmp_eq_u32 vcc, 0, v5
    s_nop 1
    v_cndmask_b32 v24, 0, v24, vcc
    v_cndmask_b32 v25, 0, v25, vcc
    v_cndmask_b32 v26, 0, v26, vcc
    v_cndmask_b32 v27, 0, v27, vcc
    v_and_b32 v5, 1, v2
    v_cmp_eq_u32 vcc, 0, v5
    v_mov_b32 v6, 0x44444444
    v_mov_b32 v8, 0xeeeeeeee
    v_cndmask_b32 v28, v8, v6, vcc
    v_mov_b32 v29, 0xdddddddd
    v_mov_b32 v12, 0
    v_mov_b32 v13, 0
    v_mov_b32 v14, 0
    v_mov_b32 v15, 0
    s_add_u32 m0, s43, 32768
    s_add_u32 s47, s38, 1
    s_and_b32 s47, s47, 7
    s_lshl_b32 s47, s47, 13
    s_add_u32 s47, s47, s43
    buffer_load_dwordx4 v20, s[12:15], s47 offen lds
    s_add_u32 m0, s43, 122880
    s_add_u32 s47, s38, 1
    s_and_b32 s47, s47, 7
    s_lshl_b32 s47, s47, 8
    s_add_u32 s47, s47, s60
    buffer_load_dwordx4 v18, s[4:7], s47 offen lds
    s_add_u32 m0, s43, 114688
    s_add_u32 s47, s38, 1
    s_and_b32 s47, s47, 7
    s_lshl_b32 s47, s47, 8
    s_add_u32 s47, s47, s60
    s_add_u32 s47, s47, 128
    buffer_load_dwordx4 v18, s[4:7], s47 offen lds
    s_add_u32 m0, s43, 40960
    s_add_u32 s47, s38, 2
    s_and_b32 s47, s47, 7
    s_lshl_b32 s47, s47, 13
    s_add_u32 s47, s47, s43
    buffer_load_dwordx4 v20, s[12:15], s47 offen lds
    s_add_u32 m0, s43, 106496
    s_add_u32 s47, s38, 2
    s_and_b32 s47, s47, 7
    s_lshl_b32 s47, s47, 8
    s_add_u32 s47, s47, s60
    buffer_load_dwordx4 v18, s[4:7], s47 offen lds
    s_add_u32 m0, s43, 98304
    s_add_u32 s47, s38, 2
    s_and_b32 s47, s47, 7
    s_lshl_b32 s47, s47, 8
    s_add_u32 s47, s47, s60
    s_add_u32 s47, s47, 128
    buffer_load_dwordx4 v18, s[4:7], s47 offen lds
    s_waitcnt lgkmcnt(0)
    s_waitcnt vmcnt(6)
    s_barrier
    ds_read_b128 v[128:131], v40 offset:8192
    ds_read_b128 v[132:135], v41 offset:8192
    ds_read_b128 v[136:139], v42 offset:8192
    ds_read_b128 v[140:143], v43 offset:8192
    s_add_u32 m0, s43, 49152
    s_add_u32 s47, s38, 3
    s_and_b32 s47, s47, 7
    s_lshl_b32 s47, s47, 13
    s_add_u32 s47, s47, s43
    buffer_load_dwordx4 v20, s[12:15], s47 offen lds
    s_add_u32 m0, s43, 90112
    s_add_u32 s47, s38, 3
    s_and_b32 s47, s47, 7
    s_lshl_b32 s47, s47, 8
    s_add_u32 s47, s47, s60
    buffer_load_dwordx4 v18, s[4:7], s47 offen lds
    s_bitcmp1_b32 s3, 1
    s_mov_b32 s48, 139264
    s_cselect_b32 s48, 131072, s48
    v_mul_u32_u24 v8, s48, v98
    v_add_u32 v100, v8, v96
    v_add_u32 v101, v8, v97
    v_add_u32 v102, 147456, v103
    ds_read_b128 v[64:67], v100
    ds_read_b128 v[68:71], v101
    ds_read_b64_tr_b16 v[72:73], v102 offset:0
    ds_read_b64_tr_b16 v[74:75], v102 offset:256
    ds_read_b64_tr_b16 v[76:77], v102 offset:1024
    ds_read_b64_tr_b16 v[78:79], v102 offset:1280
    v_add_u32 v96, v99, v96
    v_add_u32 v97, v99, v97
    s_add_u32 m0, s43, 81920
    s_add_u32 s47, s38, 3
    s_and_b32 s47, s47, 7
    s_lshl_b32 s47, s47, 8
    s_add_u32 s47, s47, s60
    s_add_u32 s47, s47, 128
    buffer_load_dwordx4 v18, s[4:7], s47 offen lds
    s_add_u32 m0, s43, 57344
    s_add_u32 s47, s38, 4
    s_and_b32 s47, s47, 7
    s_lshl_b32 s47, s47, 13
    s_add_u32 s47, s47, s43
    buffer_load_dwordx4 v20, s[12:15], s47 offen lds
    s_add_u32 m0, s43, 0
    s_add_u32 s47, s38, 4
    s_and_b32 s47, s47, 7
    s_lshl_b32 s47, s47, 8
    s_add_u32 s47, s47, s60
    buffer_load_dwordx4 v18, s[4:7], s47 offen lds
    s_add_u32 m0, s43, 8192
    s_add_u32 s47, s38, 4
    s_and_b32 s47, s47, 7
    s_lshl_b32 s47, s47, 8
    s_add_u32 s47, s47, s60
    s_add_u32 s47, s47, 128
    buffer_load_dwordx4 v18, s[4:7], s47 offen lds
    ds_read_b128 v[144:147], v40 offset:0
    ds_read_b128 v[148:151], v41 offset:0
    ds_read_b128 v[152:155], v42 offset:0
    ds_read_b128 v[156:159], v43 offset:0
    s_waitcnt vmcnt(9)
    s_barrier
    ds_read_b128 v[160:163], v36 offset:57344
    ds_read_b128 v[164:167], v37 offset:57344
    ds_read_b128 v[168:171], v38 offset:57344
    ds_read_b128 v[172:175], v39 offset:57344
    s_add_u32 m0, s43, 73728
    s_add_u32 s47, s38, 5
    s_and_b32 s47, s47, 7
    s_lshl_b32 s47, s47, 13
    s_add_u32 s47, s47, s43
    buffer_load_dwordx4 v20, s[12:15], s47 offen lds
    s_add_u32 m0, s43, 16384
    s_add_u32 s47, s38, 5
    s_and_b32 s47, s47, 7
    s_lshl_b32 s47, s47, 8
    s_add_u32 s47, s47, s60
    buffer_load_dwordx4 v18, s[4:7], s47 offen lds
    s_bitcmp1_b32 s3, 1
    s_mov_b32 s48, 122880
    s_cselect_b32 s48, 114688, s48
    v_mul_u32_u24 v8, s48, v98
    v_add_u32 v100, v8, v96
    v_add_u32 v101, v8, v97
    v_add_u32 v102, 32768, v103
    ds_read_b128 v[80:83], v100
    ds_read_b128 v[84:87], v101
    ds_read_b64_tr_b16 v[88:89], v102 offset:0
    ds_read_b64_tr_b16 v[90:91], v102 offset:256
    ds_read_b64_tr_b16 v[92:93], v102 offset:1024
    ds_read_b64_tr_b16 v[94:95], v102 offset:1280
    v_add_u32 v96, v99, v96
    v_add_u32 v97, v99, v97
    s_add_u32 m0, s43, 24576
    s_add_u32 s47, s38, 5
    s_and_b32 s47, s47, 7
    s_lshl_b32 s47, s47, 8
    s_add_u32 s47, s47, s60
    s_add_u32 s47, s47, 128
    buffer_load_dwordx4 v18, s[4:7], s47 offen lds
    s_add_u32 m0, s43, 65536
    s_add_u32 s47, s38, 6
    s_and_b32 s47, s47, 7
    s_lshl_b32 s47, s47, 13
    s_add_u32 s47, s47, s43
    buffer_load_dwordx4 v20, s[12:15], s47 offen lds
    s_waitcnt lgkmcnt(10)
    s_cmp_eq_u32 s44, 2
    s_cbranch_scc0 L_3
    v_mfma_f32_32x32x16_bf16 v[48:63], v[64:67], v[64:67], 0
    v_mfma_f32_32x32x16_bf16 v[48:63], v[68:71], v[68:71], v[48:63]
    s_branch L_4
L_3:
    s_cmp_eq_u32 s44, 0
    s_cbranch_scc0 L_5
    v_mfma_f32_32x32x16_bf16 v[48:63], v[72:75], v[64:67], 0
    v_mfma_f32_32x32x16_bf16 v[48:63], v[76:79], v[68:71], v[48:63]
    s_branch L_6
L_5:
    v_mfma_f32_32x32x16_bf16 v[48:63], v[64:67], v[72:75], 0
    v_mfma_f32_32x32x16_bf16 v[48:63], v[68:71], v[76:79], v[48:63]
L_6:
L_4:
    ds_read_b128 v[176:179], v36 offset:49152
    ds_read_b128 v[180:183], v37 offset:49152
    ds_read_b128 v[184:187], v38 offset:49152
    ds_read_b128 v[188:191], v39 offset:49152
    s_waitcnt vmcnt(10)
    s_barrier
    ds_read_b128 v[192:195], v36 offset:40960
    ds_read_b128 v[196:199], v37 offset:40960
    ds_read_b128 v[200:203], v38 offset:40960
    ds_read_b128 v[204:207], v39 offset:40960
    s_cmp_eq_u32 s3, 4
    s_cbranch_scc0 L_7
    global_load_dword v16, v1, s[90:91] sc1
L_7:
    s_add_u32 m0, s43, 147456
    s_add_u32 s47, s38, 6
    s_and_b32 s47, s47, 7
    s_lshl_b32 s47, s47, 8
    s_add_u32 s47, s47, s60
    buffer_load_dwordx4 v18, s[4:7], s47 offen lds
    s_bitcmp1_b32 s3, 1
    s_mov_b32 s48, 106496
    s_cselect_b32 s48, 98304, s48
    v_mul_u32_u24 v8, s48, v98
    v_add_u32 v100, v8, v96
    v_add_u32 v101, v8, v97
    v_add_u32 v102, 40960, v103
    ds_read_b128 v[64:67], v100
    ds_read_b128 v[68:71], v101
    ds_read_b64_tr_b16 v[72:73], v102 offset:0
    ds_read_b64_tr_b16 v[74:75], v102 offset:256
    ds_read_b64_tr_b16 v[76:77], v102 offset:1024
    ds_read_b64_tr_b16 v[78:79], v102 offset:1280
    v_add_u32 v96, v99, v96
    v_add_u32 v97, v99, v97
    s_add_u32 m0, s43, 139264
    s_add_u32 s47, s38, 6
    s_and_b32 s47, s47, 7
    s_lshl_b32 s47, s47, 8
    s_add_u32 s47, s47, s60
    s_add_u32 s47, s47, 128
    buffer_load_dwordx4 v18, s[4:7], s47 offen lds
    s_add_u32 m0, s43, 131072
    s_add_u32 s47, s38, 7
    s_and_b32 s47, s47, 7
    s_lshl_b32 s47, s47, 13
    s_add_u32 s47, s47, s43
    buffer_load_dwordx4 v20, s[12:15], s47 offen lds
    s_waitcnt lgkmcnt(10)
    s_cmp_eq_u32 s44, 2
    s_cbranch_scc0 L_8
    v_mfma_f32_32x32x16_bf16 v[48:63], v[80:83], v[80:83], v[48:63]
    v_mfma_f32_32x32x16_bf16 v[48:63], v[84:87], v[84:87], v[48:63]
    s_branch L_9
L_8:
    s_cmp_eq_u32 s44, 0
    s_cbranch_scc0 L_10
    v_mfma_f32_32x32x16_bf16 v[48:63], v[88:91], v[80:83], v[48:63]
    v_mfma_f32_32x32x16_bf16 v[48:63], v[92:95], v[84:87], v[48:63]
    s_branch L_11
L_10:
    v_mfma_f32_32x32x16_bf16 v[48:63], v[80:83], v[88:91], v[48:63]
    v_mfma_f32_32x32x16_bf16 v[48:63], v[84:87], v[92:95], v[48:63]
L_11:
L_9:
    ds_read_b128 v[208:211], v36 offset:32768
    ds_read_b128 v[212:215], v37 offset:32768
    ds_read_b128 v[216:219], v38 offset:32768
    ds_read_b128 v[220:223], v39 offset:32768
    s_waitcnt vmcnt(10)
    s_barrier
    ds_read_b128 v[224:227], v36 offset:24576
    ds_read_b128 v[228:231], v37 offset:24576
    ds_read_b128 v[232:235], v38 offset:24576
    ds_read_b128 v[236:239], v39 offset:24576
    s_add_u32 m0, s43, 122880
    s_add_u32 s47, s38, 7
    s_and_b32 s47, s47, 7
    s_lshl_b32 s47, s47, 8
    s_add_u32 s47, s47, s60
    buffer_load_dwordx4 v18, s[4:7], s47 offen lds
    s_bitcmp1_b32 s3, 1
    s_mov_b32 s48, 90112
    s_cselect_b32 s48, 81920, s48
    v_mul_u32_u24 v8, s48, v98
    v_add_u32 v100, v8, v96
    v_add_u32 v101, v8, v97
    v_add_u32 v102, 49152, v103
    ds_read_b128 v[80:83], v100
    ds_read_b128 v[84:87], v101
    ds_read_b64_tr_b16 v[88:89], v102 offset:0
    ds_read_b64_tr_b16 v[90:91], v102 offset:256
    ds_read_b64_tr_b16 v[92:93], v102 offset:1024
    ds_read_b64_tr_b16 v[94:95], v102 offset:1280
    v_add_u32 v96, v99, v96
    v_add_u32 v97, v99, v97
    s_add_u32 m0, s43, 114688
    s_add_u32 s47, s38, 7
    s_and_b32 s47, s47, 7
    s_lshl_b32 s47, s47, 8
    s_add_u32 s47, s47, s60
    s_add_u32 s47, s47, 128
    buffer_load_dwordx4 v18, s[4:7], s47 offen lds
    s_waitcnt lgkmcnt(10)
    s_cmp_eq_u32 s44, 2
    s_cbranch_scc0 L_12
    v_mfma_f32_32x32x16_bf16 v[48:63], v[64:67], v[64:67], v[48:63]
    v_mfma_f32_32x32x16_bf16 v[48:63], v[68:71], v[68:71], v[48:63]
    s_branch L_13
L_12:
    s_cmp_eq_u32 s44, 0
    s_cbranch_scc0 L_14
    v_mfma_f32_32x32x16_bf16 v[48:63], v[72:75], v[64:67], v[48:63]
    v_mfma_f32_32x32x16_bf16 v[48:63], v[76:79], v[68:71], v[48:63]
    s_branch L_15
L_14:
    v_mfma_f32_32x32x16_bf16 v[48:63], v[64:67], v[72:75], v[48:63]
    v_mfma_f32_32x32x16_bf16 v[48:63], v[68:71], v[76:79], v[48:63]
L_15:
L_13:
    ds_read_b128 v[240:243], v36 offset:16384
    ds_read_b128 v[244:247], v37 offset:16384
    ds_read_b128 v[248:251], v38 offset:16384
    ds_read_b128 v[252:255], v39 offset:16384
    s_waitcnt vmcnt(6)
    s_barrier
    v_lshrrev_b32 v8, 3, v3
    v_lshlrev_b32 v8, 11, v8
    v_and_b32 v10, 7, v2
    v_lshl_add_u32 v8, v10, 7, v8
    s_lshr_b32 s39, s2, 3
    s_lshl_b32 s39, s39, 16
    s_add_u32 s39, s39, s63
    s_lshl_b32 s40, s53, 10
    s_add_u32 s39, s39, s40
    buffer_load_dword v47, v8, s[8:11], s39 offen
    s_bitcmp1_b32 s3, 1
    s_mov_b32 s48, 0
    s_cselect_b32 s48, 8192, s48
    v_mul_u32_u24 v8, s48, v98
    v_add_u32 v100, v8, v96
    v_add_u32 v101, v8, v97
    v_add_u32 v102, 57344, v103
    ds_read_b128 v[64:67], v100
    ds_read_b128 v[68:71], v101
    ds_read_b64_tr_b16 v[72:73], v102 offset:0
    ds_read_b64_tr_b16 v[74:75], v102 offset:256
    ds_read_b64_tr_b16 v[76:77], v102 offset:1024
    ds_read_b64_tr_b16 v[78:79], v102 offset:1280
    v_add_u32 v96, v99, v96
    v_add_u32 v97, v99, v97
    s_waitcnt lgkmcnt(6)
    s_cmp_eq_u32 s44, 2
    s_cbranch_scc0 L_16
    v_mfma_f32_32x32x16_bf16 v[48:63], v[80:83], v[80:83], v[48:63]
    v_mfma_f32_32x32x16_bf16 v[48:63], v[84:87], v[84:87], v[48:63]
    s_branch L_17
L_16:
    s_cmp_eq_u32 s44, 0
    s_cbranch_scc0 L_18
    v_mfma_f32_32x32x16_bf16 v[48:63], v[88:91], v[80:83], v[48:63]
    v_mfma_f32_32x32x16_bf16 v[48:63], v[92:95], v[84:87], v[48:63]
    s_branch L_19
L_18:
    v_mfma_f32_32x32x16_bf16 v[48:63], v[80:83], v[88:91], v[48:63]
    v_mfma_f32_32x32x16_bf16 v[48:63], v[84:87], v[92:95], v[48:63]
L_19:
L_17:
    s_bitcmp1_b32 s3, 1
    s_mov_b32 s48, 16384
    s_cselect_b32 s48, 24576, s48
    v_mul_u32_u24 v8, s48, v98
    v_add_u32 v100, v8, v96
    v_add_u32 v101, v8, v97
    v_add_u32 v102, 73728, v103
    ds_read_b128 v[80:83], v100
    ds_read_b128 v[84:87], v101
    ds_read_b64_tr_b16 v[88:89], v102 offset:0
    ds_read_b64_tr_b16 v[90:91], v102 offset:256
    ds_read_b64_tr_b16 v[92:93], v102 offset:1024
    ds_read_b64_tr_b16 v[94:95], v102 offset:1280
    v_add_u32 v96, v99, v96
    v_add_u32 v97, v99, v97
    s_waitcnt lgkmcnt(6)
    s_cmp_eq_u32 s44, 2
    s_cbranch_scc0 L_20
    v_mfma_f32_32x32x16_bf16 v[48:63], v[64:67], v[64:67], v[48:63]
    v_mfma_f32_32x32x16_bf16 v[48:63], v[68:71], v[68:71], v[48:63]
    s_branch L_21
L_20:
    s_cmp_eq_u32 s44, 0
    s_cbranch_scc0 L_22
    v_mfma_f32_32x32x16_bf16 v[48:63], v[72:75], v[64:67], v[48:63]
    v_mfma_f32_32x32x16_bf16 v[48:63], v[76:79], v[68:71], v[48:63]
    s_branch L_23
L_22:
    v_mfma_f32_32x32x16_bf16 v[48:63], v[64:67], v[72:75], v[48:63]
    v_mfma_f32_32x32x16_bf16 v[48:63], v[68:71], v[76:79], v[48:63]
L_23:
L_21:
    s_waitcnt vmcnt(1)
    s_barrier
    s_bitcmp1_b32 s3, 1
    s_mov_b32 s48, 147456
    s_cselect_b32 s48, 139264, s48
    v_mul_u32_u24 v8, s48, v98
    v_add_u32 v100, v8, v96
    v_add_u32 v101, v8, v97
    v_add_u32 v102, 65536, v103
    ds_read_b128 v[64:67], v100
    ds_read_b128 v[68:71], v101
    ds_read_b64_tr_b16 v[72:73], v102 offset:0
    ds_read_b64_tr_b16 v[74:75], v102 offset:256
    ds_read_b64_tr_b16 v[76:77], v102 offset:1024
    ds_read_b64_tr_b16 v[78:79], v102 offset:1280
    v_add_u32 v96, v99, v96
    v_add_u32 v97, v99, v97
    s_waitcnt lgkmcnt(6)
    s_cmp_eq_u32 s44, 2
    s_cbranch_scc0 L_24
    v_mfma_f32_32x32x16_bf16 v[48:63], v[80:83], v[80:83], v[48:63]
    v_mfma_f32_32x32x16_bf16 v[48:63], v[84:87], v[84:87], v[48:63]
    s_branch L_25
L_24:
    s_cmp_eq_u32 s44, 0
    s_cbranch_scc0 L_26
    v_mfma_f32_32x32x16_bf16 v[48:63], v[88:91], v[80:83], v[48:63]
    v_mfma_f32_32x32x16_bf16 v[48:63], v[92:95], v[84:87], v[48:63]
    s_branch L_27
L_26:
    v_mfma_f32_32x32x16_bf16 v[48:63], v[80:83], v[88:91], v[48:63]
    v_mfma_f32_32x32x16_bf16 v[48:63], v[84:87], v[92:95], v[48:63]
L_27:
L_25:
    s_bitcmp1_b32 s3, 1
    s_mov_b32 s48, 122880
    s_cselect_b32 s48, 114688, s48
    v_mul_u32_u24 v8, s48, v98
    v_add_u32 v100, v8, v96
    v_add_u32 v101, v8, v97
    v_add_u32 v102, 131072, v103
    ds_read_b128 v[80:83], v100
    ds_read_b128 v[84:87], v101
    ds_read_b64_tr_b16 v[88:89], v102 offset:0
    ds_read_b64_tr_b16 v[90:91], v102 offset:256
    ds_read_b64_tr_b16 v[92:93], v102 offset:1024
    ds_read_b64_tr_b16 v[94:95], v102 offset:1280
    v_add_u32 v96, v99, v96
    v_add_u32 v97, v99, v97
    s_waitcnt lgkmcnt(6)
    s_cmp_eq_u32 s44, 2
    s_cbranch_scc0 L_28
    v_mfma_f32_32x32x16_bf16 v[48:63], v[64:67], v[64:67], v[48:63]
    v_mfma_f32_32x32x16_bf16 v[48:63], v[68:71], v[68:71], v[48:63]
    s_branch L_29
L_28:
    s_cmp_eq_u32 s44, 0
    s_cbranch_scc0 L_30
    v_mfma_f32_32x32x16_bf16 v[48:63], v[72:75], v[64:67], v[48:63]
    v_mfma_f32_32x32x16_bf16 v[48:63], v[76:79], v[68:71], v[48:63]
    s_branch L_31
L_30:
    v_mfma_f32_32x32x16_bf16 v[48:63], v[64:67], v[72:75], v[48:63]
    v_mfma_f32_32x32x16_bf16 v[48:63], v[68:71], v[76:79], v[48:63]
L_31:
L_29:
    s_waitcnt lgkmcnt(0)
    s_cmp_eq_u32 s44, 2
    s_cbranch_scc0 L_32
    v_mfma_f32_32x32x16_bf16 v[48:63], v[80:83], v[80:83], v[48:63]
    v_mfma_f32_32x32x16_bf16 v[48:63], v[84:87], v[84:87], v[48:63]
    s_branch L_33
L_32:
    s_cmp_eq_u32 s44, 0
    s_cbranch_scc0 L_34
    v_mfma_f32_32x32x16_bf16 v[48:63], v[88:91], v[80:83], v[48:63]
    v_mfma_f32_32x32x16_bf16 v[48:63], v[92:95], v[84:87], v[48:63]
    s_branch L_35
L_34:
    v_mfma_f32_32x32x16_bf16 v[48:63], v[80:83], v[88:91], v[48:63]
    v_mfma_f32_32x32x16_bf16 v[48:63], v[84:87], v[92:95], v[48:63]
L_35:
L_33:
    v_add_u32 v8, s45, v20
    s_nop 10
    ds_write_b128 v8, v[48:51] offset:32768
    ds_write_b128 v8, v[52:55] offset:33792
    ds_write_b128 v8, v[56:59] offset:34816
    ds_write_b128 v8, v[60:63] offset:35840
    s_waitcnt lgkmcnt(0)
    s_barrier
    s_cmp_eq_u32 s3, 4
    s_cbranch_scc0 L_36
    v_and_b32 v5, 15, v2
    v_lshlrev_b32 v6, 4, v5
    ds_read_b64 v[80:81], v6 offset:51200
    ds_read_b64 v[82:83], v6 offset:55296
    ds_read_b64 v[84:85], v6 offset:59392
    ds_read_b64 v[86:87], v6 offset:63488
    v_bfe_u32 v8, v5, 2, 1
    v_lshl_add_u32 v8, v8, 9, v6
    v_lshrrev_b32 v9, 3, v5
    v_lshl_add_u32 v8, v9, 10, v8
    v_and_b32 v9, 3, v5
    v_lshl_add_u32 v8, v9, 2, v8
    ds_read_b32 v88, v8 offset:49152
    ds_read_b32 v89, v8 offset:53248
    ds_read_b32 v90, v8 offset:57344
    ds_read_b32 v91, v8 offset:61440
    v_mov_b32 v9, 260
    ds_read_b32 v92, v9 offset:51200
    ds_read_b32 v93, v9 offset:55296
    ds_read_b32 v94, v9 offset:59392
    ds_read_b32 v95, v9 offset:63488
    s_lshl_b32 s39, s2, 8
    s_add_u32 s39, s39, 0x50000
    v_lshlrev_b32 v8, 2, v2
    buffer_store_dword v17, v8, s[16:19], s39 offen sc1
    s_add_u32 s39, s39, 0x18000
    buffer_store_dword v17, v8, s[16:19], s39 offen sc1
    s_waitcnt lgkmcnt(0)
    s_cmp_eq_u32 s53, 0
    s_cbranch_scc0 L_37
    v_add_f32 v80, v80, v82
    v_add_f32 v88, v88, v89
    v_add_f32 v81, v81, v83
    v_add_f32 v80, v80, v84
    v_add_f32 v88, v88, v90
    v_add_f32 v81, v81, v85
    v_add_f32 v80, v80, v86
    v_add_f32 v88, v88, v91
    v_add_f32 v81, v81, v87
    v_mul_f32 v80, 0x3a800000, v80
    v_add_f32 v92, v92, v93
    v_add_f32 v92, v92, v94
    v_mul_f32 v88, 0x3a800000, v88
    v_add_f32 v92, v92, v95
    s_lshl_b32 s39, s52, 4
    v_fma_f32 v88, -v80, v80, v88
    v_add_u32 v9, s39, v5
    v_sub_u32 v9, 0xffff, v9
    v_max_f32 v88, 0, v88
    v_lshlrev_b32 v6, 3, v5
    s_lshl_b32 s39, s52, 7
    v_cvt_pk_bf16_f32 v82, v80, v80
    s_add_u32 s39, s39, 0x40000
    s_lshl_b32 s40, s52, 2
    v_cvt_pk_bf16_f32 v88, v88, v88
    s_add_u32 s40, s40, 0x46000
    v_lshlrev_b32 v82, 16, v82
    v_lshlrev_b32 v88, 16, v88
    v_add_f32 v88, 0x3727c5ac, v88
    v_cvt_pk_bf16_f32 v88, v88, v88
    v_lshlrev_b32 v88, 16, v88
    v_sqrt_f32 v88, v88
    s_nop 0
    v_cvt_pk_bf16_f32 v88, v88, v88
    v_lshlrev_b32 v88, 16, v88
    v_rcp_f32 v83, v88
    v_fma_f32 v81, -v82, v92, v81
    s_mov_b64 exec, 0xffff
    buffer_store_dwordx2 v[82:83], v6, s[16:19], s39 offen sc1
    v_mul_f32 v81, v81, v83
    v_cvt_pk_bf16_f32 v81, v81, v81
    v_ashrrev_i32 v8, 31, v81
    v_or_b32 v8, 0x80000000, v8
    v_xor_b32 v81, v81, v8
    v_and_b32 v81, 0xffff0000, v81
    v_or_b32 v81, v81, v9
    s_nop 1
    v_max_u32_dpp v81, v81, v81 row_ror:8 row_mask:0xf bank_mask:0xf
    s_nop 1
    v_max_u32_dpp v81, v81, v81 row_ror:4 row_mask:0xf bank_mask:0xf
    s_nop 1
    v_max_u32_dpp v81, v81, v81 row_ror:2 row_mask:0xf bank_mask:0xf
    s_nop 1
    v_max_u32_dpp v81, v81, v81 row_ror:1 row_mask:0xf bank_mask:0xf
    s_mov_b64 exec, 1
    buffer_store_dword v81, v6, s[16:19], s40 offen sc1
    s_mov_b64 exec, -1
L_37:
L_36:
    s_cmp_lt_u32 s66, 2
    s_cbranch_scc0 L_38
    v_and_b32 v5, 15, v2
    v_lshlrev_b32 v6, 4, v5
    ds_read_b64 v[80:81], v6 offset:51200
    ds_read_b64 v[82:83], v6 offset:55296
    ds_read_b64 v[84:85], v6 offset:59392
    ds_read_b64 v[86:87], v6 offset:63488
    v_bfe_u32 v8, v5, 2, 1
    v_lshl_add_u32 v8, v8, 9, v6
    v_lshrrev_b32 v9, 3, v5
    v_lshl_add_u32 v8, v9, 10, v8
    v_and_b32 v9, 3, v5
    v_lshl_add_u32 v8, v9, 2, v8
    ds_read_b32 v88, v8 offset:49152
    ds_read_b32 v89, v8 offset:53248
    ds_read_b32 v90, v8 offset:57344
    ds_read_b32 v91, v8 offset:61440
    s_lshr_b32 s41, s52, 1
    s_lshl_b32 s41, s41, 12
    s_and_b32 s40, s52, 1
    s_cmp_eq_u32 s53, 0
    s_cbranch_scc0 L_39
    v_bfe_u32 v9, v2, 4, 1
    v_lshlrev_b32 v8, 9, v9
    v_lshl_add_u32 v8, v4, 10, v8
    s_lshl_b32 s39, s66, 11
    v_add_u32 v8, s39, v8
    v_add_u32 v9, v6, v8
    ds_read_b128 v[96:99], v9 offset:32768
    ds_read_b128 v[100:103], v9 offset:36864
    ds_read_b128 v[104:107], v9 offset:40960
    ds_read_b128 v[108:111], v9 offset:45056
    ds_read_b128 v[112:115], v8 offset:33024
    ds_read_b128 v[116:119], v8 offset:37120
    ds_read_b128 v[120:123], v8 offset:41216
    ds_read_b128 v[124:127], v8 offset:45312
    v_and_b32 v8, 3, v5
    v_bfe_u32 v9, v5, 2, 1
    v_lshl_add_u32 v8, v9, 3, v8
    v_bfe_u32 v9, v5, 3, 1
    v_lshl_add_u32 v8, v9, 2, v8
    v_bfe_u32 v9, v2, 4, 1
    v_lshl_add_u32 v8, v9, 5, v8
    v_lshlrev_b32 v8, 4, v8
    v_lshl_add_u32 v8, v4, 3, v8
    s_lshl_b32 s39, s66, 10
    s_add_u32 s41, s41, s39
    s_lshl_b32 s40, s40, 8
    s_add_u32 s41, s41, s40
    s_waitcnt lgkmcnt(0)
    v_add_f32 v80, v80, v82
    v_add_f32 v88, v88, v89
    v_add_f32 v81, v81, v83
    v_add_f32 v80, v80, v84
    v_add_f32 v88, v88, v90
    v_add_f32 v81, v81, v85
    v_add_f32 v80, v80, v86
    v_add_f32 v88, v88, v91
    v_add_f32 v81, v81, v87
    v_mul_f32 v80, 0x3a800000, v80
    v_add_f32 v96, v96, v100
    v_add_f32 v97, v97, v101
    v_mul_f32 v88, 0x3a800000, v88
    v_add_f32 v98, v98, v102
    v_add_f32 v99, v99, v103
    v_fma_f32 v88, -v80, v80, v88
    v_add_f32 v96, v96, v104
    v_add_f32 v97, v97, v105
    v_max_f32 v88, 0, v88
    v_add_f32 v98, v98, v106
    v_add_f32 v99, v99, v107
    v_cvt_pk_bf16_f32 v82, v80, v80
    v_add_f32 v96, v96, v108
    v_add_f32 v97, v97, v109
    v_cvt_pk_bf16_f32 v88, v88, v88
    v_add_f32 v98, v98, v110
    v_add_f32 v99, v99, v111
    v_lshlrev_b32 v82, 16, v82
    v_add_f32 v112, v112, v116
    v_add_f32 v113, v113, v117
    v_lshlrev_b32 v88, 16, v88
    v_add_f32 v114, v114, v118
    v_add_f32 v115, v115, v119
    v_add_f32 v88, 0x3727c5ac, v88
    v_add_f32 v112, v112, v120
    v_add_f32 v113, v113, v121
    v_cvt_pk_bf16_f32 v88, v88, v88
    v_add_f32 v114, v114, v122
    v_add_f32 v115, v115, v123
    v_lshlrev_b32 v88, 16, v88
    v_add_f32 v112, v112, v124
    v_add_f32 v113, v113, v125
    v_sqrt_f32 v88, v88
    v_add_f32 v114, v114, v126
    v_add_f32 v115, v115, v127
    v_cvt_pk_bf16_f32 v88, v88, v88
    v_lshlrev_b32 v88, 16, v88
    v_rcp_f32 v83, v88
    v_fma_f32 v96, -v82, v112, v96
    v_fma_f32 v97, -v82, v113, v97
    v_fma_f32 v98, -v82, v114, v98
    v_fma_f32 v99, -v82, v115, v99
    v_mul_f32 v96, v96, v83
    v_mul_f32 v97, v97, v83
    v_mul_f32 v98, v98, v83
    v_mul_f32 v99, v99, v83
    s_branch L_40
L_39:
    s_lshl_b32 s39, s66, 8
    v_add_u32 v10, s39, v6
    v_bfe_u32 v11, v2, 4, 1
    v_lshl_add_u32 v8, v11, 9, v10
    v_lshl_add_u32 v9, v4, 10, v8
    ds_read_b128 v[96:99], v9 offset:32768
    ds_read_b128 v[100:103], v9 offset:36864
    ds_read_b128 v[104:107], v9 offset:40960
    ds_read_b128 v[108:111], v9 offset:45056
    ds_read_b32 v112, v10 offset:34816
    ds_read_b32 v113, v10 offset:38912
    ds_read_b32 v114, v10 offset:43008
    ds_read_b32 v115, v10 offset:47104
    v_lshl_add_u32 v8, v4, 3, v8
    s_lshl_b32 s40, s40, 10
    s_add_u32 s41, s41, s40
    s_add_u32 s41, s41, 2048
    v_and_b32 v6, 0x30, v2
    s_waitcnt lgkmcnt(0)
    v_add_f32 v80, v80, v82
    v_add_f32 v88, v88, v89
    v_add_f32 v81, v81, v83
    v_add_f32 v80, v80, v84
    v_add_f32 v88, v88, v90
    v_add_f32 v81, v81, v85
    v_add_f32 v80, v80, v86
    v_add_f32 v88, v88, v91
    v_add_f32 v81, v81, v87
    v_mul_f32 v80, 0x3a800000, v80
    v_add_f32 v96, v96, v100
    v_add_f32 v97, v97, v101
    v_mul_f32 v88, 0x3a800000, v88
    v_add_f32 v98, v98, v102
    v_add_f32 v99, v99, v103
    v_fma_f32 v88, -v80, v80, v88
    v_add_f32 v96, v96, v104
    v_add_f32 v97, v97, v105
    v_max_f32 v88, 0, v88
    v_add_f32 v98, v98, v106
    v_add_f32 v99, v99, v107
    v_cvt_pk_bf16_f32 v82, v80, v80
    v_add_f32 v96, v96, v108
    v_add_f32 v97, v97, v109
    v_cvt_pk_bf16_f32 v88, v88, v88
    v_add_f32 v98, v98, v110
    v_add_f32 v99, v99, v111
    v_lshlrev_b32 v82, 16, v82
    v_add_f32 v112, v112, v113
    v_add_f32 v112, v112, v114
    v_lshlrev_b32 v88, 16, v88
    v_add_f32 v112, v112, v115
    v_add_f32 v88, 0x3727c5ac, v88
    v_cvt_pk_bf16_f32 v88, v88, v88
    v_lshlrev_b32 v88, 16, v88
    v_sqrt_f32 v88, v88
    s_nop 0
    v_cvt_pk_bf16_f32 v88, v88, v88
    v_lshlrev_b32 v88, 16, v88
    v_rcp_f32 v83, v88
    ds_bpermute_b32 v116, v6, v82 offset:0
    ds_bpermute_b32 v117, v6, v82 offset:4
    ds_bpermute_b32 v118, v6, v82 offset:8
    ds_bpermute_b32 v119, v6, v82 offset:12
    ds_bpermute_b32 v120, v6, v83 offset:0
    ds_bpermute_b32 v121, v6, v83 offset:4
    ds_bpermute_b32 v122, v6, v83 offset:8
    ds_bpermute_b32 v123, v6, v83 offset:12
    s_waitcnt lgkmcnt(4)
    v_fma_f32 v96, -v116, v112, v96
    v_fma_f32 v97, -v117, v112, v97
    v_fma_f32 v98, -v118, v112, v98
    v_fma_f32 v99, -v119, v112, v99
    s_waitcnt lgkmcnt(0)
    v_mul_f32 v96, v96, v120
    v_mul_f32 v97, v97, v121
    v_mul_f32 v98, v98, v122
    v_mul_f32 v99, v99, v123
L_40:
    v_cvt_pk_bf16_f32 v108, v96, v97
    v_cvt_pk_bf16_f32 v109, v98, v99
    buffer_store_dwordx2 v[108:109], v8, s[16:19], s41 offen sc1
L_38:
    s_add_u32 m0, s43, 65536
    s_add_u32 s47, s38, 0
    s_and_b32 s47, s47, 7
    s_lshl_b32 s47, s47, 18
    s_add_u32 s47, s47, s59
    buffer_load_dwordx4 v19, s[8:11], s47 offen lds
    s_add_u32 m0, s43, 73728
    s_add_u32 s47, s38, 0
    s_and_b32 s47, s47, 7
    s_lshl_b32 s47, s47, 18
    s_add_u32 s47, s47, s59
    s_add_u32 s47, s47, 32768
    buffer_load_dwordx4 v19, s[8:11], s47 offen lds
    s_add_u32 m0, s43, 81920
    s_add_u32 s47, s38, 0
    s_and_b32 s47, s47, 7
    s_lshl_b32 s47, s47, 18
    s_add_u32 s47, s47, s59
    s_add_u32 s47, s47, 131072
    buffer_load_dwordx4 v19, s[8:11], s47 offen lds
    s_add_u32 m0, s43, 90112
    s_add_u32 s47, s38, 0
    s_and_b32 s47, s47, 7
    s_lshl_b32 s47, s47, 18
    s_add_u32 s47, s47, s59
    s_add_u32 s47, s47, 163840
    buffer_load_dwordx4 v19, s[8:11], s47 offen lds
    s_add_u32 m0, s43, 98304
    s_add_u32 s47, s38, 1
    s_and_b32 s47, s47, 7
    s_lshl_b32 s47, s47, 18
    s_add_u32 s47, s47, s59
    buffer_load_dwordx4 v19, s[8:11], s47 offen lds
    s_add_u32 m0, s43, 106496
    s_add_u32 s47, s38, 1
    s_and_b32 s47, s47, 7
    s_lshl_b32 s47, s47, 18
    s_add_u32 s47, s47, s59
    s_add_u32 s47, s47, 32768
    buffer_load_dwordx4 v19, s[8:11], s47 offen lds
    s_add_u32 m0, s43, 131072
    s_add_u32 s47, s38, 1
    s_and_b32 s47, s47, 7
    s_lshl_b32 s47, s47, 18
    s_add_u32 s47, s47, s59
    s_add_u32 s47, s47, 131072
    buffer_load_dwordx4 v19, s[8:11], s47 offen lds
    s_add_u32 s39, s66, 1
    s_cmp_lt_u32 s39, 3
    s_cbranch_scc0 L_41
    s_waitcnt vmcnt(7)
    s_mov_b32 s61, 0
L_42:
    v_cmp_eq_u32 vcc, 0, v16
    s_add_u32 s61, s61, 1
    s_cbranch_vccz L_43
    global_load_dword v16, v1, s[90:91] sc1
    s_waitcnt vmcnt(0)
    s_cmp_lt_u32 s61, 200000
    s_cbranch_scc1 L_42
L_43:
    v_mov_b32 v8, 1
    v_mov_b32 v9, 158080
    s_mov_b64 exec, 1
    ds_add_rtn_u32 v9, v9, v8
    s_waitcnt lgkmcnt(0)
    v_cmp_eq_u32 vcc, 2, v9
    s_mov_b64 exec, 0xff
    s_cbranch_vccz L_44
    s_lshr_b32 s39, s2, 3
    s_lshl_b32 s39, s39, 7
    s_add_u32 s39, s39, 0x60000
    v_lshlrev_b32 v9, 12, v2
    buffer_atomic_add v8, v9, s[16:19], s39 offen sc1
L_44:
    s_mov_b64 exec, -1
L_41:
    s_waitcnt vmcnt(6)
    ds_read_b64_tr_b16 v[64:65], v45 offset:0
    ds_read_b64_tr_b16 v[66:67], v45 offset:256
    s_waitcnt vmcnt(5)
    ds_read_b64_tr_b16 v[68:69], v45 offset:8192
    ds_read_b64_tr_b16 v[70:71], v45 offset:8448
    s_waitcnt vmcnt(4)
    ds_read_b64_tr_b16 v[72:73], v45 offset:16384
    ds_read_b64_tr_b16 v[74:75], v45 offset:16640
    s_waitcnt vmcnt(3)
    ds_read_b64_tr_b16 v[76:77], v45 offset:24576
    ds_read_b64_tr_b16 v[78:79], v45 offset:24832
    s_waitcnt lgkmcnt(6)
    v_mfma_f32_32x32x16_bf16 v[80:95], v[64:67], v[128:131], 0
    v_mfma_f32_32x32x16_bf16 v[48:63], v[64:67], v[136:139], 0
    s_add_u32 m0, s43, 65536
    s_add_u32 s47, s38, 1
    s_and_b32 s47, s47, 7
    s_lshl_b32 s47, s47, 18
    s_add_u32 s47, s47, s59
    s_add_u32 s47, s47, 163840
    buffer_load_dwordx4 v19, s[8:11], s47 offen lds
    s_waitcnt lgkmcnt(4)
    v_mfma_f32_32x32x16_bf16 v[80:95], v[68:71], v[132:135], v[80:95]
    v_mfma_f32_32x32x16_bf16 v[48:63], v[68:71], v[140:143], v[48:63]
    s_add_u32 m0, s43, 73728
    s_add_u32 s47, s38, 2
    s_and_b32 s47, s47, 7
    s_lshl_b32 s47, s47, 18
    s_add_u32 s47, s47, s59
    buffer_load_dwordx4 v19, s[8:11], s47 offen lds
    v_smfmac_f32_16x16x64_bf16 v[12:15], v[24:27], v[64:71], v28
    s_waitcnt vmcnt(4)
    ds_read_b64_tr_b16 v[64:65], v45 offset:32768
    ds_read_b64_tr_b16 v[66:67], v45 offset:33024
    s_waitcnt vmcnt(3)
    ds_read_b64_tr_b16 v[68:69], v45 offset:40960
    ds_read_b64_tr_b16 v[70:71], v45 offset:41216
    s_waitcnt lgkmcnt(6)
    v_mfma_f32_32x32x16_bf16 v[80:95], v[72:75], v[144:147], v[80:95]
    s_add_u32 m0, s43, 81920
    s_add_u32 s47, s38, 2
    s_and_b32 s47, s47, 7
    s_lshl_b32 s47, s47, 18
    s_add_u32 s47, s47, s59
    s_add_u32 s47, s47, 32768
    buffer_load_dwordx4 v19, s[8:11], s47 offen lds
    v_mfma_f32_32x32x16_bf16 v[48:63], v[72:75], v[152:155], v[48:63]
    s_waitcnt vmcnt(3)
    ds_read_b64_tr_b16 v[128:129], v46 offset:0
    ds_read_b64_tr_b16 v[130:131], v46 offset:256
    s_waitcnt lgkmcnt(6)
    v_mfma_f32_32x32x16_bf16 v[80:95], v[76:79], v[148:151], v[80:95]
    s_add_u32 m0, s43, 90112
    s_add_u32 s47, s38, 2
    s_and_b32 s47, s47, 7
    s_lshl_b32 s47, s47, 18
    s_add_u32 s47, s47, s59
    s_add_u32 s47, s47, 131072
    buffer_load_dwordx4 v19, s[8:11], s47 offen lds
    v_mfma_f32_32x32x16_bf16 v[48:63], v[76:79], v[156:159], v[48:63]
    s_waitcnt vmcnt(3)
    ds_read_b64_tr_b16 v[132:133], v45 offset:0
    ds_read_b64_tr_b16 v[134:135], v45 offset:256
    v_smfmac_f32_16x16x64_bf16 v[12:15], v[24:27], v[72:79], v28
    s_waitcnt lgkmcnt(6)
    v_mfma_f32_32x32x16_bf16 v[80:95], v[64:67], v[160:163], v[80:95]
    s_add_u32 m0, s43, 98304
    s_add_u32 s47, s38, 2
    s_and_b32 s47, s47, 7
    s_lshl_b32 s47, s47, 18
    s_add_u32 s47, s47, s59
    s_add_u32 s47, s47, 163840
    buffer_load_dwordx4 v19, s[8:11], s47 offen lds
    v_mfma_f32_32x32x16_bf16 v[48:63], v[64:67], v[168:171], v[48:63]
    s_waitcnt vmcnt(3)
    ds_read_b64_tr_b16 v[136:137], v45 offset:8192
    ds_read_b64_tr_b16 v[138:139], v45 offset:8448
    s_waitcnt lgkmcnt(6)
    v_mfma_f32_32x32x16_bf16 v[80:95], v[68:71], v[164:167], v[80:95]
    s_add_u32 m0, s43, 106496
    s_add_u32 s47, s38, 3
    s_and_b32 s47, s47, 7
    s_lshl_b32 s47, s47, 18
    s_add_u32 s47, s47, s59
    buffer_load_dwordx4 v19, s[8:11], s47 offen lds
    v_mfma_f32_32x32x16_bf16 v[48:63], v[68:71], v[172:175], v[48:63]
    s_waitcnt vmcnt(3)
    ds_read_b64_tr_b16 v[140:141], v45 offset:16384
    ds_read_b64_tr_b16 v[142:143], v45 offset:16640
    v_smfmac_f32_16x16x64_bf16 v[12:15], v[24:27], v[64:71], v28
    s_barrier
    s_waitcnt lgkmcnt(6)
    v_mfma_f32_32x32x16_bf16 v[80:95], v[128:131], v[176:179], v[80:95]
    s_add_u32 m0, s43, 131072
    s_add_u32 s47, s38, 3
    s_and_b32 s47, s47, 7
    s_lshl_b32 s47, s47, 18
    s_add_u32 s47, s47, s59
    s_add_u32 s47, s47, 32768
    buffer_load_dwordx4 v19, s[8:11], s47 offen lds
    v_mfma_f32_32x32x16_bf16 v[48:63], v[128:131], v[184:187], v[48:63]
    s_waitcnt vmcnt(3)
    ds_read_b64_tr_b16 v[72:73], v45 offset:24576
    ds_read_b64_tr_b16 v[74:75], v45 offset:24832
    s_waitcnt lgkmcnt(6)
    v_mfma_f32_32x32x16_bf16 v[80:95], v[132:135], v[180:183], v[80:95]
    s_add_u32 m0, s43, 65536
    s_add_u32 s47, s38, 3
    s_and_b32 s47, s47, 7
    s_lshl_b32 s47, s47, 18
    s_add_u32 s47, s47, s59
    s_add_u32 s47, s47, 131072
    buffer_load_dwordx4 v19, s[8:11], s47 offen lds
    v_mfma_f32_32x32x16_bf16 v[48:63], v[132:135], v[188:191], v[48:63]
    s_waitcnt vmcnt(3)
    ds_read_b64_tr_b16 v[76:77], v45 offset:32768
    ds_read_b64_tr_b16 v[78:79], v45 offset:33024
    v_smfmac_f32_16x16x64_bf16 v[12:15], v[24:27], v[128:135], v28
    s_add_u32 m0, s43, 32768
    s_add_u32 s47, s38, 3
    s_and_b32 s47, s47, 7
    s_lshl_b32 s47, s47, 18
    s_add_u32 s47, s47, s59
    s_add_u32 s47, s47, 163840
    buffer_load_dwordx4 v19, s[8:11], s47 offen lds
    s_waitcnt lgkmcnt(6)
    v_mfma_f32_32x32x16_bf16 v[80:95], v[136:139], v[192:195], v[80:95]
    s_add_u32 m0, s43, 73728
    s_add_u32 s47, s38, 4
    s_and_b32 s47, s47, 7
    s_lshl_b32 s47, s47, 18
    s_add_u32 s47, s47, s59
    buffer_load_dwordx4 v19, s[8:11], s47 offen lds
    v_mfma_f32_32x32x16_bf16 v[48:63], v[136:139], v[200:203], v[48:63]
    s_waitcnt vmcnt(4)
    ds_read_b64_tr_b16 v[144:145], v45 offset:40960
    ds_read_b64_tr_b16 v[146:147], v45 offset:41216
    s_waitcnt lgkmcnt(6)
    v_mfma_f32_32x32x16_bf16 v[80:95], v[140:143], v[196:199], v[80:95]
    s_add_u32 m0, s43, 81920
    s_add_u32 s47, s38, 4
    s_and_b32 s47, s47, 7
    s_lshl_b32 s47, s47, 18
    s_add_u32 s47, s47, s59
    s_add_u32 s47, s47, 32768
    buffer_load_dwordx4 v19, s[8:11], s47 offen lds
    v_mfma_f32_32x32x16_bf16 v[48:63], v[140:143], v[204:207], v[48:63]
    s_waitcnt vmcnt(4)
    ds_read_b64_tr_b16 v[148:149], v46 offset:0
    ds_read_b64_tr_b16 v[150:151], v46 offset:256
    v_smfmac_f32_16x16x64_bf16 v[12:15], v[24:27], v[136:143], v28
    s_add_u32 m0, s43, 40960
    s_add_u32 s47, s38, 4
    s_and_b32 s47, s47, 7
    s_lshl_b32 s47, s47, 18
    s_add_u32 s47, s47, s59
    s_add_u32 s47, s47, 131072
    buffer_load_dwordx4 v19, s[8:11], s47 offen lds
    s_waitcnt lgkmcnt(6)
    v_mfma_f32_32x32x16_bf16 v[80:95], v[72:75], v[208:211], v[80:95]
    s_add_u32 m0, s43, 90112
    s_add_u32 s47, s38, 4
    s_and_b32 s47, s47, 7
    s_lshl_b32 s47, s47, 18
    s_add_u32 s47, s47, s59
    s_add_u32 s47, s47, 163840
    buffer_load_dwordx4 v19, s[8:11], s47 offen lds
    v_mfma_f32_32x32x16_bf16 v[48:63], v[72:75], v[216:219], v[48:63]
    s_waitcnt vmcnt(5)
    ds_read_b64_tr_b16 v[152:153], v45 offset:0
    ds_read_b64_tr_b16 v[154:155], v45 offset:256
    s_waitcnt lgkmcnt(6)
    v_mfma_f32_32x32x16_bf16 v[80:95], v[76:79], v[212:215], v[80:95]
    s_add_u32 m0, s43, 98304
    s_add_u32 s47, s38, 5
    s_and_b32 s47, s47, 7
    s_lshl_b32 s47, s47, 18
    s_add_u32 s47, s47, s59
    buffer_load_dwordx4 v19, s[8:11], s47 offen lds
    v_mfma_f32_32x32x16_bf16 v[48:63], v[76:79], v[220:223], v[48:63]
    s_waitcnt vmcnt(5)
    ds_read_b64_tr_b16 v[156:157], v44 offset:32768
    ds_read_b64_tr_b16 v[158:159], v44 offset:33024
    v_smfmac_f32_16x16x64_bf16 v[12:15], v[24:27], v[72:79], v28
    s_add_u32 m0, s43, 49152
    s_add_u32 s47, s38, 5
    s_and_b32 s47, s47, 7
    s_lshl_b32 s47, s47, 18
    s_add_u32 s47, s47, s59
    s_add_u32 s47, s47, 32768
    buffer_load_dwordx4 v19, s[8:11], s47 offen lds
    s_add_u32 s66, s63, 98304
    v_lshrrev_b32 v168, 3, v2
    v_mul_u32_u24 v168, 7168, v168
    v_and_b32 v169, 7, v2
    v_lshl_add_u32 v160, v169, 4, v168
    v_bfe_u32 v168, v2, 2, 2
    v_lshrrev_b32 v169, 4, v2
    v_lshl_add_u32 v169, v169, 3, v168
    v_lshlrev_b32 v169, 7, v169
    v_and_b32 v170, 3, v2
    v_lshl_add_u32 v169, v170, 3, v169
    v_add_u32 v161, s66, v169
    s_waitcnt lgkmcnt(6)
    v_mfma_f32_32x32x16_bf16 v[80:95], v[144:147], v[224:227], v[80:95]
    s_add_u32 m0, s43, 106496
    s_add_u32 s47, s38, 5
    s_and_b32 s47, s47, 7
    s_lshl_b32 s47, s47, 18
    s_add_u32 s47, s47, s59
    s_add_u32 s47, s47, 131072
    buffer_load_dwordx4 v19, s[8:11], s47 offen lds
    v_mfma_f32_32x32x16_bf16 v[48:63], v[144:147], v[232:235], v[48:63]
    ds_read_b128 v[128:131], v32 offset:0
    ds_read_b128 v[176:179], v34 offset:0
    s_waitcnt vmcnt(6)
    ds_read_b64_tr_b16 v[64:65], v45 offset:8192
    ds_read_b64_tr_b16 v[66:67], v45 offset:8448
    s_waitcnt lgkmcnt(8)
    v_mfma_f32_32x32x16_bf16 v[80:95], v[148:151], v[228:231], v[80:95]
    s_add_u32 m0, s43, 131072
    s_add_u32 s47, s38, 5
    s_and_b32 s47, s47, 7
    s_lshl_b32 s47, s47, 18
    s_add_u32 s47, s47, s59
    s_add_u32 s47, s47, 163840
    buffer_load_dwordx4 v19, s[8:11], s47 offen lds
    v_mfma_f32_32x32x16_bf16 v[48:63], v[148:151], v[236:239], v[48:63]
    ds_read_b128 v[132:135], v33 offset:0
    ds_read_b128 v[180:183], v35 offset:0
    s_waitcnt vmcnt(6)
    ds_read_b64_tr_b16 v[68:69], v45 offset:16384
    ds_read_b64_tr_b16 v[70:71], v45 offset:16640
    v_smfmac_f32_16x16x64_bf16 v[12:15], v[24:27], v[144:151], v28
    s_add_u32 m0, s43, 57344
    s_add_u32 s47, s38, 6
    s_and_b32 s47, s47, 7
    s_lshl_b32 s47, s47, 18
    s_add_u32 s47, s47, s59
    buffer_load_dwordx4 v19, s[8:11], s47 offen lds
    v_lshrrev_b32 v169, 4, v2
    v_lshlrev_b32 v171, 2, v169
    v_xor_b32 v171, v171, v2
    v_and_b32 v171, 15, v171
    v_lshlrev_b32 v171, 4, v171
    v_lshl_add_u32 v171, v169, 11, v171
    s_lshl_b32 s39, s3, 8
    v_add_u32 v162, s39, v171
    v_mul_u32_u24 v168, 320, v168
    v_lshl_add_u32 v168, v4, 11, v168
    v_bfe_u32 v169, v2, 4, 1
    v_lshl_add_u32 v168, v169, 5, v168
    v_lshl_add_u32 v168, v170, 3, v168
    v_add_u32 v163, s66, v168
    v_lshlrev_b32 v165, 2, v2
    v_and_b32 v168, 60, v165
    v_mov_b32 v169, 0
    s_waitcnt lgkmcnt(10)
    v_mfma_f32_32x32x16_bf16 v[80:95], v[152:155], v[240:243], v[80:95]
    s_add_u32 m0, s43, 65536
    s_add_u32 s47, s38, 6
    s_and_b32 s47, s47, 7
    s_lshl_b32 s47, s47, 18
    s_add_u32 s47, s47, s59
    s_add_u32 s47, s47, 32768
    buffer_load_dwordx4 v19, s[8:11], s47 offen lds
    v_mfma_f32_32x32x16_bf16 v[48:63], v[152:155], v[248:251], v[48:63]
    ds_read_b128 v[136:139], v32 offset:8192
    ds_read_b128 v[192:195], v34 offset:8192
    s_waitcnt vmcnt(7)
    ds_read_b64_tr_b16 v[184:185], v44 offset:40960
    ds_read_b64_tr_b16 v[186:187], v44 offset:41216
    s_waitcnt lgkmcnt(12)
    v_mfma_f32_32x32x16_bf16 v[80:95], v[156:159], v[244:247], v[80:95]
    s_add_u32 m0, s43, 32768
    s_add_u32 s47, s38, 6
    s_and_b32 s47, s47, 7
    s_lshl_b32 s47, s47, 18
    s_add_u32 s47, s47, s59
    s_add_u32 s47, s47, 131072
    buffer_load_dwordx4 v19, s[8:11], s47 offen lds
    v_mfma_f32_32x32x16_bf16 v[48:63], v[156:159], v[252:255], v[48:63]
    ds_read_b128 v[140:143], v33 offset:8192
    ds_read_b128 v[196:199], v35 offset:8192
    s_waitcnt vmcnt(7)
    ds_read_b64_tr_b16 v[188:189], v45 offset:24576
    ds_read_b64_tr_b16 v[190:191], v45 offset:24832
    v_smfmac_f32_16x16x64_bf16 v[12:15], v[24:27], v[152:159], v28
    s_and_b32 s39, s56, 3
    s_lshl_b32 s39, s39, 3
    s_add_u32 s39, s39, s3
    s_lshl_b32 s48, s39, 6
    s_mul_i32 s67, s39, 229376
    s_lshr_b32 s40, s56, 2
    s_lshl_b32 s41, s40, 7
    s_add_u32 s67, s67, s41
    s_lshl_b32 s65, s40, 8
    s_add_u32 s65, s65, 0x58000
    s_lshl_b32 s94, s56, 15
    s_and_b32 s95, s2, 7
    s_lshl_b32 s95, s95, 12
    s_lshl_b32 s39, s3, 9
    s_add_u32 s95, s95, s39
    s_add_u32 s95, s95, 0x50000
    s_cmp_lt_u32 s2, 224
    s_cselect_b32 s67, s67, 0x40000000
    s_cselect_b32 s94, s94, 0x40000000
    s_cselect_b32 s95, s95, 0x40000000
    s_cselect_b32 s65, s65, 0x40000000
    s_mov_b32 s12, s86
    s_and_b32 s13, s87, 0xffff
    s_mov_b32 s14, 0x700000
    s_mov_b32 s15, 0x20000
    s_mov_b32 s24, s88
    s_and_b32 s25, s89, 0xffff
    s_mov_b32 s26, 0x400000
    s_mov_b32 s27, 0x20000
    s_waitcnt lgkmcnt(12)
    v_mfma_f32_32x32x16_bf16 v[80:95], v[64:67], v[128:131], v[80:95]
    s_add_u32 m0, s43, 73728
    s_add_u32 s47, s38, 6
    s_and_b32 s47, s47, 7
    s_lshl_b32 s47, s47, 18
    s_add_u32 s47, s47, s59
    s_add_u32 s47, s47, 163840
    buffer_load_dwordx4 v19, s[8:11], s47 offen lds
    v_mfma_f32_32x32x16_bf16 v[48:63], v[64:67], v[176:179], v[48:63]
    ds_read_b128 v[72:75], v32 offset:16384
    ds_read_b128 v[144:147], v34 offset:16384
    s_waitcnt lgkmcnt(10)
    v_mfma_f32_32x32x16_bf16 v[80:95], v[68:71], v[132:135], v[80:95]
    s_waitcnt vmcnt(7)
    ds_read_b64_tr_b16 v[200:201], v45 offset:32768
    ds_read_b64_tr_b16 v[202:203], v45 offset:33024
    s_add_u32 m0, s43, 81920
    s_add_u32 s47, s38, 7
    s_and_b32 s47, s47, 7
    s_lshl_b32 s47, s47, 18
    s_add_u32 s47, s47, s59
    buffer_load_dwordx4 v19, s[8:11], s47 offen lds
    v_mfma_f32_32x32x16_bf16 v[48:63], v[68:71], v[180:183], v[48:63]
    ds_read_b128 v[76:79], v33 offset:16384
    ds_read_b128 v[148:151], v35 offset:16384
    v_smfmac_f32_16x16x64_bf16 v[12:15], v[24:27], v[64:71], v28
    s_waitcnt vmcnt(7)
    ds_read_b64_tr_b16 v[204:205], v44 offset:49152
    ds_read_b64_tr_b16 v[206:207], v44 offset:49408
    v_lshlrev_b32 v122, 7, v3
    s_and_b32 s42, s2, 7
    s_lshl_b32 s42, s42, 12
    s_add_u32 s42, s42, 0x60000
    s_cmp_eq_u32 s3, 4
    s_cbranch_scc0 L_45
    buffer_load_dword v123, v122, s[16:19], s42 offen sc1
L_45:
    s_waitcnt lgkmcnt(12)
    v_mfma_f32_32x32x16_bf16 v[80:95], v[184:187], v[136:139], v[80:95]
    s_add_u32 m0, s43, 40960
    s_add_u32 s47, s38, 7
    s_and_b32 s47, s47, 7
    s_lshl_b32 s47, s47, 18
    s_add_u32 s47, s47, s59
    s_add_u32 s47, s47, 32768
    buffer_load_dwordx4 v19, s[8:11], s47 offen lds
    v_mfma_f32_32x32x16_bf16 v[48:63], v[184:187], v[192:195], v[48:63]
    ds_read_b128 v[240:243], v32 offset:24576
    ds_read_b128 v[248:251], v34 offset:24576
    s_waitcnt lgkmcnt(10)
    v_mfma_f32_32x32x16_bf16 v[80:95], v[188:191], v[140:143], v[80:95]
    s_waitcnt vmcnt(7)
    ds_read_b64_tr_b16 v[152:153], v45 offset:40960
    ds_read_b64_tr_b16 v[154:155], v45 offset:41216
    s_add_u32 m0, s43, 90112
    s_add_u32 s47, s38, 7
    s_and_b32 s47, s47, 7
    s_lshl_b32 s47, s47, 18
    s_add_u32 s47, s47, s59
    s_add_u32 s47, s47, 131072
    buffer_load_dwordx4 v19, s[8:11], s47 offen lds
    v_mfma_f32_32x32x16_bf16 v[48:63], v[188:191], v[196:199], v[48:63]
    ds_read_b128 v[244:247], v33 offset:24576
    ds_read_b128 v[252:255], v35 offset:24576
    v_smfmac_f32_16x16x64_bf16 v[12:15], v[24:27], v[184:191], v28
    s_waitcnt vmcnt(7)
    ds_read_b64_tr_b16 v[156:157], v46 offset:0
    ds_read_b64_tr_b16 v[158:159], v46 offset:256
    s_waitcnt lgkmcnt(12)
    v_mfma_f32_32x32x16_bf16 v[80:95], v[200:203], v[72:75], v[80:95]
    s_add_u32 m0, s43, 98304
    s_add_u32 s47, s38, 7
    s_and_b32 s47, s47, 7
    s_lshl_b32 s47, s47, 18
    s_add_u32 s47, s47, s59
    s_add_u32 s47, s47, 163840
    buffer_load_dwordx4 v19, s[8:11], s47 offen lds
    v_mfma_f32_32x32x16_bf16 v[48:63], v[200:203], v[144:147], v[48:63]
    ds_read_b128 v[128:131], v40 offset:16384
    ds_read_b128 v[176:179], v42 offset:16384
    s_waitcnt lgkmcnt(10)
    v_mfma_f32_32x32x16_bf16 v[80:95], v[204:207], v[76:79], v[80:95]
    s_waitcnt vmcnt(7)
    ds_read_b64_tr_b16 v[64:65], v44 offset:57344
    ds_read_b64_tr_b16 v[66:67], v44 offset:57600
    v_mfma_f32_32x32x16_bf16 v[48:63], v[204:207], v[148:151], v[48:63]
    ds_read_b128 v[132:135], v41 offset:16384
    ds_read_b128 v[180:183], v43 offset:16384
    v_smfmac_f32_16x16x64_bf16 v[12:15], v[24:27], v[200:207], v28
    s_waitcnt vmcnt(6)
    ds_read_b64_tr_b16 v[68:69], v45 offset:0
    ds_read_b64_tr_b16 v[70:71], v45 offset:256
    s_waitcnt lgkmcnt(12)
    v_mfma_f32_32x32x16_bf16 v[80:95], v[152:155], v[240:243], v[80:95]
    v_mfma_f32_32x32x16_bf16 v[48:63], v[152:155], v[248:251], v[48:63]
    ds_read_b128 v[136:139], v40 offset:8192
    ds_read_b128 v[192:195], v42 offset:8192
    s_waitcnt lgkmcnt(10)
    v_mfma_f32_32x32x16_bf16 v[80:95], v[156:159], v[244:247], v[80:95]
    s_waitcnt vmcnt(5)
    ds_read_b64_tr_b16 v[184:185], v44 offset:32768
    ds_read_b64_tr_b16 v[186:187], v44 offset:33024
    v_mfma_f32_32x32x16_bf16 v[48:63], v[156:159], v[252:255], v[48:63]
    ds_read_b128 v[140:143], v41 offset:8192
    ds_read_b128 v[196:199], v43 offset:8192
    v_smfmac_f32_16x16x64_bf16 v[12:15], v[24:27], v[152:159], v28
    s_waitcnt vmcnt(4)
    ds_read_b64_tr_b16 v[188:189], v45 offset:8192
    ds_read_b64_tr_b16 v[190:191], v45 offset:8448
    s_cmp_eq_u32 s3, 4
    s_cbranch_scc0 L_46
    s_waitcnt vmcnt(3)
    s_mov_b32 s61, 0
    s_branch pchk_48
poll_47:
    buffer_load_dword v123, v122, s[16:19], s42 offen sc1
    s_waitcnt vmcnt(0)
pchk_48:
    v_cmp_ne_u32 vcc, 8, v123
    s_add_u32 s61, s61, 1
    s_cbranch_vccz pdone_49
    s_sleep 2
    s_cmp_lt_u32 s61, 200000
    s_cbranch_scc1 poll_47
pdone_49:
L_46:
    s_barrier
    s_waitcnt lgkmcnt(12)
    v_mfma_f32_32x32x16_bf16 v[80:95], v[64:67], v[128:131], v[80:95]
    ds_read_b128 v[72:75], v36 offset:57344
    ds_read_b128 v[144:147], v38 offset:57344
    v_mfma_f32_32x32x16_bf16 v[48:63], v[64:67], v[176:179], v[48:63]
    s_waitcnt vmcnt(3)
    ds_read_b64_tr_b16 v[200:201], v45 offset:16384
    ds_read_b64_tr_b16 v[202:203], v45 offset:16640
    s_waitcnt lgkmcnt(12)
    v_mfma_f32_32x32x16_bf16 v[80:95], v[68:71], v[132:135], v[80:95]
    ds_read_b128 v[76:79], v37 offset:57344
    ds_read_b128 v[148:151], v39 offset:57344
    s_waitcnt vmcnt(2)
    ds_read_b64_tr_b16 v[204:205], v44 offset:40960
    ds_read_b64_tr_b16 v[206:207], v44 offset:41216
    v_mfma_f32_32x32x16_bf16 v[48:63], v[68:71], v[180:183], v[48:63]
    s_lshl_b32 s39, s51, 8
    s_add_u32 s39, s39, 0x40000
    v_lshlrev_b32 v5, 3, v3
    buffer_load_dwordx2 v[30:31], v5, s[16:19], s39 offen sc1
    v_smfmac_f32_16x16x64_bf16 v[12:15], v[24:27], v[64:71], v28
    s_xor_b32 s39, s39, 0x100
    buffer_load_dword v124, v5, s[16:19], s39 offen sc1
    s_add_u32 m0, s45, 0
    s_add_u32 s46, s45, 0
    buffer_load_dwordx4 v20, s[20:23], s46 offen sc1 lds
    s_add_u32 m0, s45, 1024
    s_add_u32 s46, s45, 1024
    buffer_load_dwordx4 v20, s[20:23], s46 offen sc1 lds
    s_waitcnt lgkmcnt(12)
    v_mfma_f32_32x32x16_bf16 v[80:95], v[184:187], v[136:139], v[80:95]
    ds_read_b128 v[240:243], v36 offset:49152
    ds_read_b128 v[248:251], v38 offset:49152
    v_mfma_f32_32x32x16_bf16 v[48:63], v[184:187], v[192:195], v[48:63]
    s_waitcnt vmcnt(5)
    ds_read_b64_tr_b16 v[152:153], v45 offset:24576
    ds_read_b64_tr_b16 v[154:155], v45 offset:24832
    s_waitcnt lgkmcnt(12)
    v_mfma_f32_32x32x16_bf16 v[80:95], v[188:191], v[140:143], v[80:95]
    ds_read_b128 v[244:247], v37 offset:49152
    ds_read_b128 v[252:255], v39 offset:49152
    s_waitcnt vmcnt(4)
    ds_read_b64_tr_b16 v[156:157], v45 offset:32768
    ds_read_b64_tr_b16 v[158:159], v45 offset:33024
    v_mfma_f32_32x32x16_bf16 v[48:63], v[188:191], v[196:199], v[48:63]
    s_add_u32 m0, s45, 2048
    s_add_u32 s46, s45, 2048
    buffer_load_dwordx4 v20, s[20:23], s46 offen sc1 lds
    v_smfmac_f32_16x16x64_bf16 v[12:15], v[24:27], v[184:191], v28
    s_add_u32 m0, s45, 3072
    s_add_u32 s46, s45, 3072
    buffer_load_dwordx4 v20, s[20:23], s46 offen sc1 lds
    v_lshlrev_b32 v5, 3, v2
    s_mov_b32 s39, 0x46000
    buffer_load_dwordx2 v[126:127], v5, s[16:19], s39 offen sc1
    s_cmp_eq_u32 s3, 6
    s_cbranch_scc0 L_50
    s_lshr_b32 s39, s2, 3
    s_lshl_b32 s39, s39, 13
    v_lshlrev_b32 v5, 7, v2
    buffer_load_dword v16, v5, s[20:23], s39 offen sc1
L_50:
    s_waitcnt lgkmcnt(8)
    v_smfmac_f32_16x16x64_bf16 v[12:15], v[24:27], v[200:207], v28
    v_mfma_f32_32x32x16_bf16 v[48:63], v[200:203], v[144:147], v[48:63]
    v_cmp_eq_u32 vcc, 0, v4
    s_waitcnt vmcnt(5)
    v_cvt_pk_bf16_f32 v224, -v30, -v30
    v_cvt_pk_bf16_f32 v228, -v124, -v124
    s_waitcnt lgkmcnt(0)
    v_smfmac_f32_16x16x64_bf16 v[12:15], v[24:27], v[152:159], v28
    v_mfma_f32_32x32x16_bf16 v[48:63], v[204:207], v[148:151], v[48:63]
    v_cndmask_b32 v224, 0, v224, vcc
    v_cndmask_b32 v228, 0, v228, vcc
    v_mov_b32 v225, v224
    v_mov_b32 v229, v228
    v_mov_b32 v226, 0
    v_mov_b32 v227, 0
    v_mov_b32 v230, 0
    v_mov_b32 v231, 0
    v_mfma_f32_32x32x16_bf16 v[48:63], v[152:155], v[248:251], v[48:63]
    v_mov_b32 v10, 0
    v_mov_b32 v11, 0
    v_add_f32 v6, v12, v13
    v_cvt_pk_bf16_f32 v5, v6, v6
    v_lshlrev_b32 v5, 16, v5
    v_sub_f32 v5, v6, v5
    v_mfma_f32_32x32x16_bf16 v[48:63], v[156:159], v[252:255], v[48:63]
    v_cvt_pk_bf16_f32 v8, v6, v5
    v_and_b32 v6, 0xffff0000, v8
    v_sub_f32 v5, v5, v6
    v_cvt_pk_bf16_f32 v9, v5, 0
    v_add_u32 v12, s43, v20
    v_add_u32 v12, 0x10000, v12
    v_mfma_f32_32x32x16_bf16 v[48:63], v[8:11], v[228:231], v[48:63]
    v_and_b32 v5, 1, v2
    v_cmp_eq_u32 vcc, 0, v5
    v_mfma_f32_32x32x16_bf16 v[80:95], v[200:203], v[72:75], v[80:95]
    v_mul_f32 v6, 0x3e8293ee, v31
    v_xor_b32 v13, 0x400, v12
    v_cndmask_b32 v24, 0, v24, vcc
    v_cndmask_b32 v25, 0, v25, vcc
    v_cndmask_b32 v26, 0, v26, vcc
    v_cndmask_b32 v27, 0, v27, vcc
    v_mfma_f32_32x32x16_bf16 v[80:95], v[204:207], v[76:79], v[80:95]
    v_pk_mov_b32 v[96:97], 0, 0
    v_pk_mov_b32 v[98:99], 0, 0
    v_pk_mov_b32 v[100:101], 0, 0
    v_pk_mov_b32 v[102:103], 0, 0
    ds_write_b128 v12, v[48:51] offset:0
    ds_write_b128 v12, v[52:55] offset:8192
    v_mfma_f32_32x32x16_bf16 v[80:95], v[152:155], v[240:243], v[80:95]
    ds_write_b128 v12, v[56:59] offset:16384
    ds_write_b128 v12, v[60:63] offset:24576
    v_pk_mov_b32 v[104:105], 0, 0
    v_pk_mov_b32 v[106:107], 0, 0
    v_pk_mov_b32 v[108:109], 0, 0
    v_pk_mov_b32 v[110:111], 0, 0
    v_mfma_f32_32x32x16_bf16 v[80:95], v[156:159], v[244:247], v[80:95]
    v_pk_mov_b32 v[112:113], 0, 0
    v_pk_mov_b32 v[114:115], 0, 0
    v_add_u32 v17, 0x10000, v20
    v_mfma_f32_32x32x16_bf16 v[80:95], v[8:11], v[224:227], v[80:95]
    s_mov_b32 s8, s76
    s_and_b32 s9, s77, 0xffff
    s_mov_b32 s10, 0x200000
    s_mov_b32 s11, 0x20000
    s_waitcnt vmcnt(1)
    s_waitcnt lgkmcnt(0)
    s_barrier
    ds_read_b128 v[208:211], v13 offset:0
    ds_read_b128 v[212:215], v13 offset:8192
    ds_read_b128 v[216:219], v13 offset:16384
    ds_read_b128 v[220:223], v13 offset:24576
    ds_read_b128 v[116:119], v20
    ds_read_b128 v[120:123], v20 offset:1024
    s_add_u32 m0, s45, 32768
    s_add_u32 s46, s45, 32768
    buffer_load_dwordx4 v20, s[20:23], s46 offen sc1 lds
    s_waitcnt lgkmcnt(5)
    v_pk_add_f32 v[80:81], v[80:81], v[208:209]
    v_pk_add_f32 v[82:83], v[82:83], v[210:211]
    v_pk_mul_f32 v[80:81], v[80:81], v[6:7] op_sel_hi:[1,0]
    v_pk_mul_f32 v[82:83], v[82:83], v[6:7] op_sel_hi:[1,0]
    v_cvt_pk_bf16_f32 v32, v80, v81
    v_cvt_pk_bf16_f32 v33, v82, v83
    s_waitcnt lgkmcnt(4)
    v_pk_add_f32 v[84:85], v[84:85], v[212:213]
    v_pk_add_f32 v[86:87], v[86:87], v[214:215]
    v_pk_mul_f32 v[84:85], v[84:85], v[6:7] op_sel_hi:[1,0]
    v_pk_mul_f32 v[86:87], v[86:87], v[6:7] op_sel_hi:[1,0]
    v_cvt_pk_bf16_f32 v34, v84, v85
    v_cvt_pk_bf16_f32 v35, v86, v87
    s_waitcnt lgkmcnt(3)
    v_pk_add_f32 v[88:89], v[88:89], v[216:217]
    v_pk_add_f32 v[90:91], v[90:91], v[218:219]
    v_pk_mul_f32 v[88:89], v[88:89], v[6:7] op_sel_hi:[1,0]
    v_pk_mul_f32 v[90:91], v[90:91], v[6:7] op_sel_hi:[1,0]
    v_cvt_pk_bf16_f32 v36, v88, v89
    v_cvt_pk_bf16_f32 v37, v90, v91
    s_waitcnt lgkmcnt(2)
    v_pk_add_f32 v[92:93], v[92:93], v[220:221]
    v_pk_add_f32 v[94:95], v[94:95], v[222:223]
    v_pk_mul_f32 v[92:93], v[92:93], v[6:7] op_sel_hi:[1,0]
    v_pk_mul_f32 v[94:95], v[94:95], v[6:7] op_sel_hi:[1,0]
    v_cvt_pk_bf16_f32 v38, v92, v93
    v_cvt_pk_bf16_f32 v39, v94, v95
    s_waitcnt lgkmcnt(0)
    v_mfma_f32_32x32x16_bf16 v[64:79], v[116:119], v[32:35], 0
    v_mfma_f32_32x32x16_bf16 v[64:79], v[120:123], v[36:39], v[64:79]
    ds_read_b128 v[116:119], v20 offset:4096
    ds_read_b128 v[120:123], v20 offset:5120
    ds_read_b128 v[56:59], v20 offset:2048
    s_nop 8
    v_max3_f32 v6, v64, v65, v66
    v_max3_f32 v5, v67, v68, v69
    v_max3_f32 v6, v6, v70, v71
    v_max3_f32 v5, v5, v72, v73
    v_max3_f32 v6, v6, v74, v75
    v_max3_f32 v5, v5, v76, v77
    v_max3_f32 v6, v6, v78, v79
    v_max_f32 v6, v6, v5
    v_mov_b32 v5, v6
    s_nop 1
    v_permlane32_swap_b32 v6, v5
    v_max_f32 v6, v6, v5
    v_sub_f32 v40, 0, v6
    v_sub_f32 v41, 0, v6
    v_pk_add_f32 v[64:65], v[64:65], v[40:41]
    v_pk_add_f32 v[66:67], v[66:67], v[40:41]
    v_pk_add_f32 v[68:69], v[68:69], v[40:41]
    v_pk_add_f32 v[70:71], v[70:71], v[40:41]
    v_pk_add_f32 v[72:73], v[72:73], v[40:41]
    v_pk_add_f32 v[74:75], v[74:75], v[40:41]
    v_pk_add_f32 v[76:77], v[76:77], v[40:41]
    v_pk_add_f32 v[78:79], v[78:79], v[40:41]
    v_pk_mov_b32 v[42:43], v[40:41], v[40:41]
    v_pk_mov_b32 v[44:45], v[40:41], v[40:41]
    v_pk_mov_b32 v[46:47], v[40:41], v[40:41]
    v_pk_mov_b32 v[48:49], v[40:41], v[40:41]
    v_pk_mov_b32 v[50:51], v[40:41], v[40:41]
    v_pk_mov_b32 v[52:53], v[40:41], v[40:41]
    v_pk_mov_b32 v[54:55], v[40:41], v[40:41]
    v_exp_f32 v64, v64
    ds_read_b128 v[60:63], v20 offset:3072
    v_exp_f32 v65, v65
    v_exp_f32 v66, v66
    v_exp_f32 v67, v67
    s_waitcnt lgkmcnt(2)
    v_exp_f32 v68, v68
    v_exp_f32 v69, v69
    v_mfma_f32_32x32x16_bf16 v[80:95], v[116:119], v[32:35], v[40:55]
    s_setprio 2
    v_exp_f32 v70, v70
    v_exp_f32 v71, v71
    v_exp_f32 v72, v72
    v_mfma_f32_32x32x16_bf16 v[80:95], v[120:123], v[36:39], v[80:95]
    ds_read_b128 v[116:119], v20 offset:8192
    ds_read_b128 v[120:123], v20 offset:9216
    v_exp_f32 v73, v73
    v_exp_f32 v74, v74
    v_exp_f32 v75, v75
    s_waitcnt lgkmcnt(3)
    v_smfmac_f32_32x32x32_bf16 v[96:111], v[56:59], v[64:71], v29
    ds_read_b128 v[56:59], v20 offset:6144
    s_add_u32 m0, s45, 33792
    s_add_u32 s46, s45, 33792
    buffer_load_dwordx4 v20, s[20:23], s46 offen sc1 lds
    v_exp_f32 v76, v76
    v_exp_f32 v77, v77
    v_exp_f32 v78, v78
    v_exp_f32 v79, v79
    v_smfmac_f32_16x16x64_bf16 v[112:115], v[24:27], v[64:71], v29
    v_exp_f32 v80, v80
    s_waitcnt lgkmcnt(3)
    v_smfmac_f32_32x32x32_bf16 v[96:111], v[60:63], v[72:79], v29
    ds_read_b128 v[60:63], v20 offset:7168
    v_exp_f32 v81, v81
    v_exp_f32 v82, v82
    v_exp_f32 v83, v83
    s_waitcnt lgkmcnt(2)
    v_smfmac_f32_16x16x64_bf16 v[112:115], v[24:27], v[72:79], v29
    v_exp_f32 v84, v84
    v_exp_f32 v85, v85
    v_mfma_f32_32x32x16_bf16 v[64:79], v[116:119], v[32:35], v[40:55]
    s_setprio 1
    v_exp_f32 v86, v86
    v_exp_f32 v87, v87
    v_exp_f32 v88, v88
    v_mfma_f32_32x32x16_bf16 v[64:79], v[120:123], v[36:39], v[64:79]
    ds_read_b128 v[116:119], v20 offset:12288
    ds_read_b128 v[120:123], v20 offset:13312
    v_exp_f32 v89, v89
    v_exp_f32 v90, v90
    v_exp_f32 v91, v91
    s_waitcnt lgkmcnt(3)
    v_smfmac_f32_32x32x32_bf16 v[96:111], v[56:59], v[80:87], v29
    ds_read_b128 v[56:59], v20 offset:10240
    s_add_u32 m0, s45, 34816
    s_add_u32 s46, s45, 34816
    buffer_load_dwordx4 v20, s[20:23], s46 offen sc1 lds
    v_exp_f32 v92, v92
    v_exp_f32 v93, v93
    v_exp_f32 v94, v94
    v_exp_f32 v95, v95
    v_smfmac_f32_16x16x64_bf16 v[112:115], v[24:27], v[80:87], v29
    s_waitcnt vmcnt(3)
    v_max_u32 v5, v126, v127
    s_nop 1
    v_max_u32_dpp v5, v5, v5 row_ror:8 row_mask:0xf bank_mask:0xf
    s_nop 1
    v_max_u32_dpp v5, v5, v5 row_ror:4 row_mask:0xf bank_mask:0xf
    s_nop 1
    v_max_u32_dpp v5, v5, v5 row_ror:2 row_mask:0xf bank_mask:0xf
    s_nop 1
    v_max_u32_dpp v5, v5, v5 row_ror:1 row_mask:0xf bank_mask:0xf
    s_nop 0
    v_readlane_b32 s39, v5, 0
    v_readlane_b32 s40, v5, 16
    v_readlane_b32 s41, v5, 32
    v_readlane_b32 s42, v5, 48
    s_max_u32 s39, s39, s40
    s_max_u32 s41, s41, s42
    s_max_u32 s55, s39, s41
    s_and_b32 s54, s55, 0xffff
    s_sub_u32 s54, 0xffff, s54
    s_and_b32 s54, s54, 2047
    v_exp_f32 v64, v64
    s_waitcnt lgkmcnt(3)
    v_smfmac_f32_32x32x32_bf16 v[96:111], v[60:63], v[88:95], v29
    ds_read_b128 v[60:63], v20 offset:11264
    v_exp_f32 v65, v65
    v_exp_f32 v66, v66
    v_exp_f32 v67, v67
    s_waitcnt lgkmcnt(2)
    v_smfmac_f32_16x16x64_bf16 v[112:115], v[24:27], v[88:95], v29
    v_exp_f32 v68, v68
    v_exp_f32 v69, v69
    v_mfma_f32_32x32x16_bf16 v[80:95], v[116:119], v[32:35], v[40:55]
    s_setprio 0
    v_exp_f32 v70, v70
    v_exp_f32 v71, v71
    v_exp_f32 v72, v72
    v_mfma_f32_32x32x16_bf16 v[80:95], v[120:123], v[36:39], v[80:95]
    ds_read_b128 v[116:119], v20 offset:16384
    ds_read_b128 v[120:123], v20 offset:17408
    v_exp_f32 v73, v73
    v_exp_f32 v74, v74
    v_exp_f32 v75, v75
    s_waitcnt lgkmcnt(3)
    v_smfmac_f32_32x32x32_bf16 v[96:111], v[56:59], v[64:71], v29
    ds_read_b128 v[56:59], v20 offset:14336
    s_add_u32 m0, s45, 35840
    s_add_u32 s46, s45, 35840
    buffer_load_dwordx4 v20, s[20:23], s46 offen sc1 lds
    v_exp_f32 v76, v76
    v_exp_f32 v77, v77
    v_exp_f32 v78, v78
    v_exp_f32 v79, v79
    v_smfmac_f32_16x16x64_bf16 v[112:115], v[24:27], v[64:71], v29
    s_add_u32 m0, s66, 0
    s_add_u32 s39, s67, 0
    buffer_load_dwordx4 v160, s[28:31], s39 offen lds
    v_exp_f32 v80, v80
    s_waitcnt lgkmcnt(3)
    v_smfmac_f32_32x32x32_bf16 v[96:111], v[60:63], v[72:79], v29
    ds_read_b128 v[60:63], v20 offset:15360
    v_exp_f32 v81, v81
    v_exp_f32 v82, v82
    v_exp_f32 v83, v83
    s_waitcnt lgkmcnt(2)
    v_smfmac_f32_16x16x64_bf16 v[112:115], v[24:27], v[72:79], v29
    v_exp_f32 v84, v84
    v_exp_f32 v85, v85
    v_mfma_f32_32x32x16_bf16 v[64:79], v[116:119], v[32:35], v[40:55]
    s_setprio 3
    v_exp_f32 v86, v86
    v_exp_f32 v87, v87
    v_exp_f32 v88, v88
    v_mfma_f32_32x32x16_bf16 v[64:79], v[120:123], v[36:39], v[64:79]
    ds_read_b128 v[116:119], v20 offset:20480
    ds_read_b128 v[120:123], v20 offset:21504
    v_exp_f32 v89, v89
    v_exp_f32 v90, v90
    v_exp_f32 v91, v91
    s_waitcnt lgkmcnt(3)
    v_smfmac_f32_32x32x32_bf16 v[96:111], v[56:59], v[80:87], v29
    ds_read_b128 v[56:59], v20 offset:18432
    v_exp_f32 v92, v92
    v_exp_f32 v93, v93
    v_exp_f32 v94, v94
    v_exp_f32 v95, v95
    v_smfmac_f32_16x16x64_bf16 v[112:115], v[24:27], v[80:87], v29
    s_lshl_b32 s39, s54, 11
    s_add_u32 s39, s39, s48
    buffer_load_dword v164, v168, s[4:7], s39 offen
    v_exp_f32 v64, v64
    s_waitcnt lgkmcnt(3)
    v_smfmac_f32_32x32x32_bf16 v[96:111], v[60:63], v[88:95], v29
    ds_read_b128 v[60:63], v20 offset:19456
    v_exp_f32 v65, v65
    v_exp_f32 v66, v66
    v_exp_f32 v67, v67
    s_waitcnt lgkmcnt(2)
    v_smfmac_f32_16x16x64_bf16 v[112:115], v[24:27], v[88:95], v29
    v_exp_f32 v68, v68
    v_exp_f32 v69, v69
    v_mfma_f32_32x32x16_bf16 v[80:95], v[116:119], v[32:35], v[40:55]
    s_setprio 2
    v_exp_f32 v70, v70
    v_exp_f32 v71, v71
    v_exp_f32 v72, v72
    v_mfma_f32_32x32x16_bf16 v[80:95], v[120:123], v[36:39], v[80:95]
    ds_read_b128 v[116:119], v20 offset:24576
    ds_read_b128 v[120:123], v20 offset:25600
    v_exp_f32 v73, v73
    v_exp_f32 v74, v74
    v_exp_f32 v75, v75
    s_waitcnt lgkmcnt(3)
    v_smfmac_f32_32x32x32_bf16 v[96:111], v[56:59], v[64:71], v29
    ds_read_b128 v[56:59], v20 offset:22528
    v_exp_f32 v76, v76
    v_exp_f32 v77, v77
    v_exp_f32 v78, v78
    v_exp_f32 v79, v79
    v_smfmac_f32_16x16x64_bf16 v[112:115], v[24:27], v[64:71], v29
    s_add_u32 m0, s66, 1024
    s_add_u32 s39, s67, 57344
    buffer_load_dwordx4 v160, s[28:31], s39 offen lds
    v_exp_f32 v80, v80
    s_waitcnt lgkmcnt(3)
    v_smfmac_f32_32x32x32_bf16 v[96:111], v[60:63], v[72:79], v29
    ds_read_b128 v[60:63], v20 offset:23552
    v_exp_f32 v81, v81
    v_exp_f32 v82, v82
    v_exp_f32 v83, v83
    s_waitcnt lgkmcnt(2)
    v_smfmac_f32_16x16x64_bf16 v[112:115], v[24:27], v[72:79], v29
    v_exp_f32 v84, v84
    v_exp_f32 v85, v85
    v_mfma_f32_32x32x16_bf16 v[64:79], v[116:119], v[32:35], v[40:55]
    s_setprio 1
    v_exp_f32 v86, v86
    v_exp_f32 v87, v87
    v_exp_f32 v88, v88
    v_mfma_f32_32x32x16_bf16 v[64:79], v[120:123], v[36:39], v[64:79]
    ds_read_b128 v[116:119], v20 offset:28672
    ds_read_b128 v[120:123], v20 offset:29696
    v_exp_f32 v89, v89
    v_exp_f32 v90, v90
    v_exp_f32 v91, v91
    s_waitcnt lgkmcnt(3)
    v_smfmac_f32_32x32x32_bf16 v[96:111], v[56:59], v[80:87], v29
    ds_read_b128 v[56:59], v20 offset:26624
    v_exp_f32 v92, v92
    v_exp_f32 v93, v93
    v_exp_f32 v94, v94
    v_exp_f32 v95, v95
    v_smfmac_f32_16x16x64_bf16 v[112:115], v[24:27], v[80:87], v29
    s_lshl_b32 s39, s54, 3
    s_add_u32 s39, s39, 0x40000
    buffer_load_dwordx2 v[166:167], v169, s[16:19], s39 offen sc1
    v_exp_f32 v64, v64
    s_waitcnt lgkmcnt(3)
    v_smfmac_f32_32x32x32_bf16 v[96:111], v[60:63], v[88:95], v29
    ds_read_b128 v[60:63], v20 offset:27648
    v_exp_f32 v65, v65
    v_exp_f32 v66, v66
    v_exp_f32 v67, v67
    s_waitcnt lgkmcnt(2)
    v_smfmac_f32_16x16x64_bf16 v[112:115], v[24:27], v[88:95], v29
    v_exp_f32 v68, v68
    v_exp_f32 v69, v69
    v_mfma_f32_32x32x16_bf16 v[80:95], v[116:119], v[32:35], v[40:55]
    s_setprio 0
    v_exp_f32 v70, v70
    v_exp_f32 v71, v71
    v_exp_f32 v72, v72
    v_mfma_f32_32x32x16_bf16 v[80:95], v[120:123], v[36:39], v[80:95]
    s_waitcnt vmcnt(4)
    s_barrier
    ds_read_b128 v[116:119], v20 offset:32768
    ds_read_b128 v[120:123], v20 offset:33792
    v_exp_f32 v73, v73
    v_exp_f32 v74, v74
    v_exp_f32 v75, v75
    s_waitcnt lgkmcnt(3)
    v_smfmac_f32_32x32x32_bf16 v[96:111], v[56:59], v[64:71], v29
    ds_read_b128 v[56:59], v20 offset:30720
    v_exp_f32 v76, v76
    v_exp_f32 v77, v77
    v_exp_f32 v78, v78
    v_exp_f32 v79, v79
    v_smfmac_f32_16x16x64_bf16 v[112:115], v[24:27], v[64:71], v29
    s_add_u32 m0, s66, 2048
    s_add_u32 s39, s67, 114688
    buffer_load_dwordx4 v160, s[28:31], s39 offen lds
    v_exp_f32 v80, v80
    s_waitcnt lgkmcnt(3)
    v_smfmac_f32_32x32x32_bf16 v[96:111], v[60:63], v[72:79], v29
    ds_read_b128 v[60:63], v20 offset:31744
    v_exp_f32 v81, v81
    v_exp_f32 v82, v82
    v_exp_f32 v83, v83
    s_waitcnt lgkmcnt(2)
    v_smfmac_f32_16x16x64_bf16 v[112:115], v[24:27], v[72:79], v29
    v_exp_f32 v84, v84
    v_exp_f32 v85, v85
    v_mfma_f32_32x32x16_bf16 v[64:79], v[116:119], v[32:35], v[40:55]
    s_setprio 3
    v_exp_f32 v86, v86
    v_exp_f32 v87, v87
    v_exp_f32 v88, v88
    v_mfma_f32_32x32x16_bf16 v[64:79], v[120:123], v[36:39], v[64:79]
    ds_read_b128 v[116:119], v20 offset:36864
    ds_read_b128 v[120:123], v20 offset:37888
    v_exp_f32 v89, v89
    v_exp_f32 v90, v90
    v_exp_f32 v91, v91
    s_waitcnt lgkmcnt(3)
    v_smfmac_f32_32x32x32_bf16 v[96:111], v[56:59], v[80:87], v29
    ds_read_b128 v[56:59], v20 offset:34816
    s_add_u32 m0, s45, 65536
    s_add_u32 s46, s45, 65536
    buffer_load_dwordx4 v20, s[20:23], s46 offen sc1 lds
    v_exp_f32 v92, v92
    v_exp_f32 v93, v93
    v_exp_f32 v94, v94
    v_exp_f32 v95, v95
    v_smfmac_f32_16x16x64_bf16 v[112:115], v[24:27], v[80:87], v29
    v_exp_f32 v64, v64
    s_waitcnt lgkmcnt(3)
    v_smfmac_f32_32x32x32_bf16 v[96:111], v[60:63], v[88:95], v29
    ds_read_b128 v[60:63], v20 offset:35840
    v_exp_f32 v65, v65
    v_exp_f32 v66, v66
    v_exp_f32 v67, v67
    s_waitcnt lgkmcnt(2)
    v_smfmac_f32_16x16x64_bf16 v[112:115], v[24:27], v[88:95], v29
    v_exp_f32 v68, v68
    v_exp_f32 v69, v69
    v_mfma_f32_32x32x16_bf16 v[80:95], v[116:119], v[32:35], v[40:55]
    s_setprio 2
    v_exp_f32 v70, v70
    v_exp_f32 v71, v71
    v_exp_f32 v72, v72
    v_mfma_f32_32x32x16_bf16 v[80:95], v[120:123], v[36:39], v[80:95]
    ds_read_b128 v[116:119], v20 offset:40960
    ds_read_b128 v[120:123], v20 offset:41984
    v_exp_f32 v73, v73
    v_exp_f32 v74, v74
    v_exp_f32 v75, v75
    s_waitcnt lgkmcnt(3)
    v_smfmac_f32_32x32x32_bf16 v[96:111], v[56:59], v[64:71], v29
    ds_read_b128 v[56:59], v20 offset:38912
    s_add_u32 m0, s45, 66560
    s_add_u32 s46, s45, 66560
    buffer_load_dwordx4 v20, s[20:23], s46 offen sc1 lds
    v_exp_f32 v76, v76
    v_exp_f32 v77, v77
    v_exp_f32 v78, v78
    v_exp_f32 v79, v79
    v_smfmac_f32_16x16x64_bf16 v[112:115], v[24:27], v[64:71], v29
    v_exp_f32 v80, v80
    s_waitcnt lgkmcnt(3)
    v_smfmac_f32_32x32x32_bf16 v[96:111], v[60:63], v[72:79], v29
    ds_read_b128 v[60:63], v20 offset:39936
    v_exp_f32 v81, v81
    v_exp_f32 v82, v82
    v_exp_f32 v83, v83
    s_waitcnt lgkmcnt(2)
    v_smfmac_f32_16x16x64_bf16 v[112:115], v[24:27], v[72:79], v29
    v_exp_f32 v84, v84
    v_exp_f32 v85, v85
    v_mfma_f32_32x32x16_bf16 v[64:79], v[116:119], v[32:35], v[40:55]
    s_setprio 1
    v_exp_f32 v86, v86
    v_exp_f32 v87, v87
    v_exp_f32 v88, v88
    v_mfma_f32_32x32x16_bf16 v[64:79], v[120:123], v[36:39], v[64:79]
    ds_read_b128 v[116:119], v20 offset:45056
    ds_read_b128 v[120:123], v20 offset:46080
    v_exp_f32 v89, v89
    v_exp_f32 v90, v90
    v_exp_f32 v91, v91
    s_waitcnt lgkmcnt(3)
    v_smfmac_f32_32x32x32_bf16 v[96:111], v[56:59], v[80:87], v29
    ds_read_b128 v[56:59], v20 offset:43008
    s_add_u32 m0, s45, 67584
    s_add_u32 s46, s45, 67584
    buffer_load_dwordx4 v20, s[20:23], s46 offen sc1 lds
    v_exp_f32 v92, v92
    v_exp_f32 v93, v93
    v_exp_f32 v94, v94
    v_exp_f32 v95, v95
    v_smfmac_f32_16x16x64_bf16 v[112:115], v[24:27], v[80:87], v29
    v_exp_f32 v64, v64
    s_waitcnt lgkmcnt(3)
    v_smfmac_f32_32x32x32_bf16 v[96:111], v[60:63], v[88:95], v29
    ds_read_b128 v[60:63], v20 offset:44032
    v_exp_f32 v65, v65
    v_exp_f32 v66, v66
    v_exp_f32 v67, v67
    s_waitcnt lgkmcnt(2)
    v_smfmac_f32_16x16x64_bf16 v[112:115], v[24:27], v[88:95], v29
    v_exp_f32 v68, v68
    v_exp_f32 v69, v69
    v_mfma_f32_32x32x16_bf16 v[80:95], v[116:119], v[32:35], v[40:55]
    s_setprio 0
    v_exp_f32 v70, v70
    v_exp_f32 v71, v71
    v_exp_f32 v72, v72
    v_mfma_f32_32x32x16_bf16 v[80:95], v[120:123], v[36:39], v[80:95]
    ds_read_b128 v[116:119], v20 offset:49152
    ds_read_b128 v[120:123], v20 offset:50176
    v_exp_f32 v73, v73
    v_exp_f32 v74, v74
    v_exp_f32 v75, v75
    s_waitcnt lgkmcnt(3)
    v_smfmac_f32_32x32x32_bf16 v[96:111], v[56:59], v[64:71], v29
    ds_read_b128 v[56:59], v20 offset:47104
    s_add_u32 m0, s45, 68608
    s_add_u32 s46, s45, 68608
    buffer_load_dwordx4 v20, s[20:23], s46 offen sc1 lds
    v_exp_f32 v76, v76
    v_exp_f32 v77, v77
    v_exp_f32 v78, v78
    v_exp_f32 v79, v79
    v_smfmac_f32_16x16x64_bf16 v[112:115], v[24:27], v[64:71], v29
    s_add_u32 m0, s66, 3072
    s_add_u32 s39, s67, 172032
    buffer_load_dwordx4 v160, s[28:31], s39 offen lds
    v_exp_f32 v80, v80
    s_waitcnt lgkmcnt(3)
    v_smfmac_f32_32x32x32_bf16 v[96:111], v[60:63], v[72:79], v29
    ds_read_b128 v[60:63], v20 offset:48128
    v_exp_f32 v81, v81
    v_exp_f32 v82, v82
    v_exp_f32 v83, v83
    s_waitcnt lgkmcnt(2)
    v_smfmac_f32_16x16x64_bf16 v[112:115], v[24:27], v[72:79], v29
    v_exp_f32 v84, v84
    v_exp_f32 v85, v85
    v_mfma_f32_32x32x16_bf16 v[64:79], v[116:119], v[32:35], v[40:55]
    s_setprio 3
    v_exp_f32 v86, v86
    v_exp_f32 v87, v87
    v_exp_f32 v88, v88
    v_mfma_f32_32x32x16_bf16 v[64:79], v[120:123], v[36:39], v[64:79]
    ds_read_b128 v[116:119], v20 offset:53248
    ds_read_b128 v[120:123], v20 offset:54272
    v_exp_f32 v89, v89
    v_exp_f32 v90, v90
    v_exp_f32 v91, v91
    s_waitcnt lgkmcnt(3)
    v_smfmac_f32_32x32x32_bf16 v[96:111], v[56:59], v[80:87], v29
    ds_read_b128 v[56:59], v20 offset:51200
    v_exp_f32 v92, v92
    v_exp_f32 v93, v93
    v_exp_f32 v94, v94
    v_exp_f32 v95, v95
    v_smfmac_f32_16x16x64_bf16 v[112:115], v[24:27], v[80:87], v29
    v_exp_f32 v64, v64
    s_waitcnt lgkmcnt(3)
    v_smfmac_f32_32x32x32_bf16 v[96:111], v[60:63], v[88:95], v29
    ds_read_b128 v[60:63], v20 offset:52224
    v_exp_f32 v65, v65
    v_exp_f32 v66, v66
    v_exp_f32 v67, v67
    s_waitcnt lgkmcnt(2)
    v_smfmac_f32_16x16x64_bf16 v[112:115], v[24:27], v[88:95], v29
    v_exp_f32 v68, v68
    v_exp_f32 v69, v69
    v_mfma_f32_32x32x16_bf16 v[80:95], v[116:119], v[32:35], v[40:55]
    s_setprio 2
    v_exp_f32 v70, v70
    v_exp_f32 v71, v71
    v_exp_f32 v72, v72
    v_mfma_f32_32x32x16_bf16 v[80:95], v[120:123], v[36:39], v[80:95]
    ds_read_b128 v[116:119], v20 offset:57344
    ds_read_b128 v[120:123], v20 offset:58368
    v_exp_f32 v73, v73
    v_exp_f32 v74, v74
    v_exp_f32 v75, v75
    s_waitcnt lgkmcnt(3)
    v_smfmac_f32_32x32x32_bf16 v[96:111], v[56:59], v[64:71], v29
    ds_read_b128 v[56:59], v20 offset:55296
    v_exp_f32 v76, v76
    v_exp_f32 v77, v77
    v_exp_f32 v78, v78
    v_exp_f32 v79, v79
    v_smfmac_f32_16x16x64_bf16 v[112:115], v[24:27], v[64:71], v29
    s_add_u32 m0, s66, 4096
    s_add_u32 s39, s67, 0
    buffer_load_dwordx4 v160, s[32:35], s39 offen lds
    v_exp_f32 v80, v80
    s_waitcnt lgkmcnt(3)
    v_smfmac_f32_32x32x32_bf16 v[96:111], v[60:63], v[72:79], v29
    ds_read_b128 v[60:63], v20 offset:56320
    v_exp_f32 v81, v81
    v_exp_f32 v82, v82
    v_exp_f32 v83, v83
    s_waitcnt lgkmcnt(2)
    v_smfmac_f32_16x16x64_bf16 v[112:115], v[24:27], v[72:79], v29
    v_exp_f32 v84, v84
    v_exp_f32 v85, v85
    v_mfma_f32_32x32x16_bf16 v[64:79], v[116:119], v[32:35], v[40:55]
    s_setprio 1
    v_exp_f32 v86, v86
    v_exp_f32 v87, v87
    v_exp_f32 v88, v88
    v_mfma_f32_32x32x16_bf16 v[64:79], v[120:123], v[36:39], v[64:79]
    ds_read_b128 v[116:119], v20 offset:61440
    ds_read_b128 v[120:123], v20 offset:62464
    v_exp_f32 v89, v89
    v_exp_f32 v90, v90
    v_exp_f32 v91, v91
    s_waitcnt lgkmcnt(3)
    v_smfmac_f32_32x32x32_bf16 v[96:111], v[56:59], v[80:87], v29
    ds_read_b128 v[56:59], v20 offset:59392
    v_exp_f32 v92, v92
    v_exp_f32 v93, v93
    v_exp_f32 v94, v94
    v_exp_f32 v95, v95
    v_smfmac_f32_16x16x64_bf16 v[112:115], v[24:27], v[80:87], v29
    v_exp_f32 v64, v64
    s_waitcnt lgkmcnt(3)
    v_smfmac_f32_32x32x32_bf16 v[96:111], v[60:63], v[88:95], v29
    ds_read_b128 v[60:63], v20 offset:60416
    v_exp_f32 v65, v65
    v_exp_f32 v66, v66
    v_exp_f32 v67, v67
    s_waitcnt lgkmcnt(2)
    v_smfmac_f32_16x16x64_bf16 v[112:115], v[24:27], v[88:95], v29
    v_exp_f32 v68, v68
    v_exp_f32 v69, v69
    v_mfma_f32_32x32x16_bf16 v[80:95], v[116:119], v[32:35], v[40:55]
    s_setprio 0
    v_exp_f32 v70, v70
    v_exp_f32 v71, v71
    v_exp_f32 v72, v72
    v_mfma_f32_32x32x16_bf16 v[80:95], v[120:123], v[36:39], v[80:95]
    s_waitcnt vmcnt(2)
    s_barrier
    ds_read_b128 v[116:119], v17 offset:0
    ds_read_b128 v[120:123], v17 offset:1024
    v_exp_f32 v73, v73
    v_exp_f32 v74, v74
    v_exp_f32 v75, v75
    s_waitcnt lgkmcnt(3)
    v_smfmac_f32_32x32x32_bf16 v[96:111], v[56:59], v[64:71], v29
    ds_read_b128 v[56:59], v20 offset:63488
    v_exp_f32 v76, v76
    v_exp_f32 v77, v77
    v_exp_f32 v78, v78
    v_exp_f32 v79, v79
    v_smfmac_f32_16x16x64_bf16 v[112:115], v[24:27], v[64:71], v29
    s_add_u32 m0, s66, 5120
    s_add_u32 s39, s67, 57344
    buffer_load_dwordx4 v160, s[32:35], s39 offen lds
    v_exp_f32 v80, v80
    s_waitcnt lgkmcnt(3)
    v_smfmac_f32_32x32x32_bf16 v[96:111], v[60:63], v[72:79], v29
    ds_read_b128 v[60:63], v20 offset:64512
    v_exp_f32 v81, v81
    v_exp_f32 v82, v82
    v_exp_f32 v83, v83
    s_waitcnt lgkmcnt(2)
    v_smfmac_f32_16x16x64_bf16 v[112:115], v[24:27], v[72:79], v29
    v_exp_f32 v84, v84
    v_exp_f32 v85, v85
    v_mfma_f32_32x32x16_bf16 v[64:79], v[116:119], v[32:35], v[40:55]
    s_setprio 3
    v_exp_f32 v86, v86
    v_exp_f32 v87, v87
    v_exp_f32 v88, v88
    v_mfma_f32_32x32x16_bf16 v[64:79], v[120:123], v[36:39], v[64:79]
    ds_read_b128 v[116:119], v17 offset:4096
    ds_read_b128 v[120:123], v17 offset:5120
    v_exp_f32 v89, v89
    v_exp_f32 v90, v90
    v_exp_f32 v91, v91
    s_waitcnt lgkmcnt(3)
    v_smfmac_f32_32x32x32_bf16 v[96:111], v[56:59], v[80:87], v29
    ds_read_b128 v[56:59], v17 offset:2048
    s_add_u32 m0, s45, 0
    s_add_u32 s46, s45, 98304
    buffer_load_dwordx4 v20, s[20:23], s46 offen sc1 lds
    v_exp_f32 v92, v92
    v_exp_f32 v93, v93
    v_exp_f32 v94, v94
    v_exp_f32 v95, v95
    v_smfmac_f32_16x16x64_bf16 v[112:115], v[24:27], v[80:87], v29
    v_exp_f32 v64, v64
    s_waitcnt lgkmcnt(3)
    v_smfmac_f32_32x32x32_bf16 v[96:111], v[60:63], v[88:95], v29
    ds_read_b128 v[60:63], v17 offset:3072
    v_exp_f32 v65, v65
    v_exp_f32 v66, v66
    v_exp_f32 v67, v67
    s_waitcnt lgkmcnt(2)
    v_smfmac_f32_16x16x64_bf16 v[112:115], v[24:27], v[88:95], v29
    v_exp_f32 v68, v68
    v_exp_f32 v69, v69
    v_mfma_f32_32x32x16_bf16 v[80:95], v[116:119], v[32:35], v[40:55]
    s_setprio 2
    v_exp_f32 v70, v70
    v_exp_f32 v71, v71
    v_exp_f32 v72, v72
    v_mfma_f32_32x32x16_bf16 v[80:95], v[120:123], v[36:39], v[80:95]
    ds_read_b128 v[116:119], v17 offset:8192
    ds_read_b128 v[120:123], v17 offset:9216
    v_exp_f32 v73, v73
    v_exp_f32 v74, v74
    v_exp_f32 v75, v75
    s_waitcnt lgkmcnt(3)
    v_smfmac_f32_32x32x32_bf16 v[96:111], v[56:59], v[64:71], v29
    ds_read_b128 v[56:59], v17 offset:6144
    s_add_u32 m0, s45, 1024
    s_add_u32 s46, s45, 99328
    buffer_load_dwordx4 v20, s[20:23], s46 offen sc1 lds
    v_exp_f32 v76, v76
    v_exp_f32 v77, v77
    v_exp_f32 v78, v78
    v_exp_f32 v79, v79
    v_smfmac_f32_16x16x64_bf16 v[112:115], v[24:27], v[64:71], v29
    v_lshlrev_b32 v168, 16, v164
    v_and_b32 v169, 0xffff0000, v164
    v_sub_f32 v168, v168, v166
    v_sub_f32 v169, v169, v166
    v_cvt_pk_bf16_f32 v170, v168, v169
    v_lshlrev_b32 v168, 16, v170
    v_and_b32 v169, 0xffff0000, v170
    v_mul_f32 v168, v168, v167
    v_mul_f32 v169, v169, v167
    v_cvt_pk_bf16_f32 v170, v168, v169
    v_and_b32 v171, 0x30, v2
    ds_bpermute_b32 v176, v171, v170 offset:0
    ds_bpermute_b32 v177, v171, v170 offset:4
    ds_bpermute_b32 v178, v171, v170 offset:8
    ds_bpermute_b32 v179, v171, v170 offset:12
    v_exp_f32 v80, v80
    s_waitcnt lgkmcnt(7)
    v_smfmac_f32_32x32x32_bf16 v[96:111], v[60:63], v[72:79], v29
    ds_read_b128 v[60:63], v17 offset:7168
    v_exp_f32 v81, v81
    v_exp_f32 v82, v82
    v_exp_f32 v83, v83
    s_waitcnt lgkmcnt(6)
    v_smfmac_f32_16x16x64_bf16 v[112:115], v[24:27], v[72:79], v29
    v_exp_f32 v84, v84
    v_exp_f32 v85, v85
    v_mfma_f32_32x32x16_bf16 v[64:79], v[116:119], v[32:35], v[40:55]
    s_setprio 1
    v_exp_f32 v86, v86
    v_exp_f32 v87, v87
    v_exp_f32 v88, v88
    v_mfma_f32_32x32x16_bf16 v[64:79], v[120:123], v[36:39], v[64:79]
    ds_read_b128 v[116:119], v17 offset:12288
    ds_read_b128 v[120:123], v17 offset:13312
    v_exp_f32 v89, v89
    v_exp_f32 v90, v90
    v_exp_f32 v91, v91
    s_waitcnt lgkmcnt(7)
    v_smfmac_f32_32x32x32_bf16 v[96:111], v[56:59], v[80:87], v29
    ds_read_b128 v[56:59], v17 offset:10240
    s_add_u32 m0, s45, 2048
    s_add_u32 s46, s45, 100352
    buffer_load_dwordx4 v20, s[20:23], s46 offen sc1 lds
    v_exp_f32 v92, v92
    v_exp_f32 v93, v93
    v_exp_f32 v94, v94
    v_exp_f32 v95, v95
    v_smfmac_f32_16x16x64_bf16 v[112:115], v[24:27], v[80:87], v29
    v_exp_f32 v64, v64
    s_waitcnt lgkmcnt(3)
    v_smfmac_f32_32x32x32_bf16 v[96:111], v[60:63], v[88:95], v29
    ds_read_b128 v[60:63], v17 offset:11264
    v_exp_f32 v65, v65
    v_exp_f32 v66, v66
    v_exp_f32 v67, v67
    s_waitcnt lgkmcnt(2)
    v_smfmac_f32_16x16x64_bf16 v[112:115], v[24:27], v[88:95], v29
    v_exp_f32 v68, v68
    v_exp_f32 v69, v69
    v_mfma_f32_32x32x16_bf16 v[80:95], v[116:119], v[32:35], v[40:55]
    s_setprio 0
    v_exp_f32 v70, v70
    v_exp_f32 v71, v71
    v_exp_f32 v72, v72
    v_mfma_f32_32x32x16_bf16 v[80:95], v[120:123], v[36:39], v[80:95]
    ds_read_b128 v[116:119], v17 offset:16384
    ds_read_b128 v[120:123], v17 offset:17408
    v_exp_f32 v73, v73
    v_exp_f32 v74, v74
    v_exp_f32 v75, v75
    s_waitcnt lgkmcnt(3)
    v_smfmac_f32_32x32x32_bf16 v[96:111], v[56:59], v[64:71], v29
    ds_read_b128 v[56:59], v17 offset:14336
    s_add_u32 m0, s45, 3072
    s_add_u32 s46, s45, 101376
    buffer_load_dwordx4 v20, s[20:23], s46 offen sc1 lds
    v_exp_f32 v76, v76
    v_exp_f32 v77, v77
    v_exp_f32 v78, v78
    v_exp_f32 v79, v79
    v_smfmac_f32_16x16x64_bf16 v[112:115], v[24:27], v[64:71], v29
    s_add_u32 m0, s66, 6144
    s_add_u32 s39, s67, 114688
    buffer_load_dwordx4 v160, s[32:35], s39 offen lds
    v_exp_f32 v80, v80
    s_waitcnt lgkmcnt(3)
    v_smfmac_f32_32x32x32_bf16 v[96:111], v[60:63], v[72:79], v29
    ds_read_b128 v[60:63], v17 offset:15360
    v_exp_f32 v81, v81
    v_exp_f32 v82, v82
    v_exp_f32 v83, v83
    s_waitcnt lgkmcnt(2)
    v_smfmac_f32_16x16x64_bf16 v[112:115], v[24:27], v[72:79], v29
    v_exp_f32 v84, v84
    v_exp_f32 v85, v85
    v_mfma_f32_32x32x16_bf16 v[64:79], v[116:119], v[32:35], v[40:55]
    s_setprio 3
    v_exp_f32 v86, v86
    v_exp_f32 v87, v87
    v_exp_f32 v88, v88
    v_mfma_f32_32x32x16_bf16 v[64:79], v[120:123], v[36:39], v[64:79]
    ds_read_b128 v[116:119], v17 offset:20480
    ds_read_b128 v[120:123], v17 offset:21504
    v_exp_f32 v89, v89
    v_exp_f32 v90, v90
    v_exp_f32 v91, v91
    s_waitcnt lgkmcnt(3)
    v_smfmac_f32_32x32x32_bf16 v[96:111], v[56:59], v[80:87], v29
    ds_read_b128 v[56:59], v17 offset:18432
    v_exp_f32 v92, v92
    v_exp_f32 v93, v93
    v_exp_f32 v94, v94
    v_exp_f32 v95, v95
    v_smfmac_f32_16x16x64_bf16 v[112:115], v[24:27], v[80:87], v29
    v_exp_f32 v64, v64
    s_waitcnt lgkmcnt(3)
    v_smfmac_f32_32x32x32_bf16 v[96:111], v[60:63], v[88:95], v29
    ds_read_b128 v[60:63], v17 offset:19456
    v_exp_f32 v65, v65
    v_exp_f32 v66, v66
    v_exp_f32 v67, v67
    s_waitcnt lgkmcnt(2)
    v_smfmac_f32_16x16x64_bf16 v[112:115], v[24:27], v[88:95], v29
    v_exp_f32 v68, v68
    v_exp_f32 v69, v69
    v_mfma_f32_32x32x16_bf16 v[80:95], v[116:119], v[32:35], v[40:55]
    s_setprio 2
    v_exp_f32 v70, v70
    v_exp_f32 v71, v71
    v_exp_f32 v72, v72
    v_mfma_f32_32x32x16_bf16 v[80:95], v[120:123], v[36:39], v[80:95]
    ds_read_b128 v[116:119], v17 offset:24576
    ds_read_b128 v[120:123], v17 offset:25600
    v_exp_f32 v73, v73
    v_exp_f32 v74, v74
    v_exp_f32 v75, v75
    s_waitcnt lgkmcnt(3)
    v_smfmac_f32_32x32x32_bf16 v[96:111], v[56:59], v[64:71], v29
    ds_read_b128 v[56:59], v17 offset:22528
    v_exp_f32 v76, v76
    v_exp_f32 v77, v77
    v_exp_f32 v78, v78
    v_exp_f32 v79, v79
    v_smfmac_f32_16x16x64_bf16 v[112:115], v[24:27], v[64:71], v29
    s_add_u32 m0, s66, 7168
    s_add_u32 s39, s67, 172032
    buffer_load_dwordx4 v160, s[32:35], s39 offen lds
    v_exp_f32 v80, v80
    s_waitcnt lgkmcnt(3)
    v_smfmac_f32_32x32x32_bf16 v[96:111], v[60:63], v[72:79], v29
    ds_read_b128 v[60:63], v17 offset:23552
    v_exp_f32 v81, v81
    v_exp_f32 v82, v82
    v_exp_f32 v83, v83
    s_waitcnt lgkmcnt(2)
    v_smfmac_f32_16x16x64_bf16 v[112:115], v[24:27], v[72:79], v29
    v_exp_f32 v84, v84
    v_exp_f32 v85, v85
    v_mfma_f32_32x32x16_bf16 v[64:79], v[116:119], v[32:35], v[40:55]
    s_setprio 1
    v_exp_f32 v86, v86
    v_exp_f32 v87, v87
    v_exp_f32 v88, v88
    v_mfma_f32_32x32x16_bf16 v[64:79], v[120:123], v[36:39], v[64:79]
    ds_read_b128 v[116:119], v17 offset:28672
    ds_read_b128 v[120:123], v17 offset:29696
    v_exp_f32 v89, v89
    v_exp_f32 v90, v90
    v_exp_f32 v91, v91
    s_waitcnt lgkmcnt(3)
    v_smfmac_f32_32x32x32_bf16 v[96:111], v[56:59], v[80:87], v29
    ds_read_b128 v[56:59], v17 offset:26624
    v_exp_f32 v92, v92
    v_exp_f32 v93, v93
    v_exp_f32 v94, v94
    v_exp_f32 v95, v95
    v_smfmac_f32_16x16x64_bf16 v[112:115], v[24:27], v[80:87], v29
    v_exp_f32 v64, v64
    s_waitcnt lgkmcnt(3)
    v_smfmac_f32_32x32x32_bf16 v[96:111], v[60:63], v[88:95], v29
    ds_read_b128 v[60:63], v17 offset:27648
    v_exp_f32 v65, v65
    v_exp_f32 v66, v66
    v_exp_f32 v67, v67
    s_waitcnt lgkmcnt(2)
    v_smfmac_f32_16x16x64_bf16 v[112:115], v[24:27], v[88:95], v29
    v_exp_f32 v68, v68
    v_exp_f32 v69, v69
    v_mfma_f32_32x32x16_bf16 v[80:95], v[116:119], v[32:35], v[40:55]
    s_setprio 0
    v_exp_f32 v70, v70
    v_exp_f32 v71, v71
    v_exp_f32 v72, v72
    v_mfma_f32_32x32x16_bf16 v[80:95], v[120:123], v[36:39], v[80:95]
    s_waitcnt vmcnt(2)
    s_barrier
    ds_read_b128 v[116:119], v20 offset:0
    ds_read_b128 v[120:123], v20 offset:1024
    v_exp_f32 v73, v73
    v_exp_f32 v74, v74
    v_exp_f32 v75, v75
    s_waitcnt lgkmcnt(3)
    v_smfmac_f32_32x32x32_bf16 v[96:111], v[56:59], v[64:71], v29
    ds_read_b128 v[56:59], v17 offset:30720
    v_exp_f32 v76, v76
    v_exp_f32 v77, v77
    v_exp_f32 v78, v78
    v_exp_f32 v79, v79
    v_smfmac_f32_16x16x64_bf16 v[112:115], v[24:27], v[64:71], v29
    ds_read_b64_tr_b16 v[192:193], v161 offset:0
    ds_read_b64_tr_b16 v[194:195], v161 offset:512
    ds_read_b64_tr_b16 v[196:197], v161 offset:32
    ds_read_b64_tr_b16 v[198:199], v161 offset:544
    v_exp_f32 v80, v80
    s_waitcnt lgkmcnt(7)
    v_smfmac_f32_32x32x32_bf16 v[96:111], v[60:63], v[72:79], v29
    ds_read_b128 v[60:63], v17 offset:31744
    v_exp_f32 v81, v81
    v_exp_f32 v82, v82
    v_exp_f32 v83, v83
    s_waitcnt lgkmcnt(6)
    v_smfmac_f32_16x16x64_bf16 v[112:115], v[24:27], v[72:79], v29
    v_exp_f32 v84, v84
    v_exp_f32 v85, v85
    v_mfma_f32_32x32x16_bf16 v[64:79], v[116:119], v[32:35], v[40:55]
    s_setprio 3
    v_exp_f32 v86, v86
    v_exp_f32 v87, v87
    v_exp_f32 v88, v88
    v_mfma_f32_32x32x16_bf16 v[64:79], v[120:123], v[36:39], v[64:79]
    ds_read_b128 v[116:119], v20 offset:4096
    ds_read_b128 v[120:123], v20 offset:5120
    v_exp_f32 v89, v89
    v_exp_f32 v90, v90
    v_exp_f32 v91, v91
    s_waitcnt lgkmcnt(7)
    v_smfmac_f32_32x32x32_bf16 v[96:111], v[56:59], v[80:87], v29
    ds_read_b128 v[56:59], v20 offset:2048
    s_add_u32 m0, s45, 32768
    s_add_u32 s46, s45, 131072
    buffer_load_dwordx4 v20, s[20:23], s46 offen sc1 lds
    v_exp_f32 v92, v92
    v_exp_f32 v93, v93
    v_exp_f32 v94, v94
    v_exp_f32 v95, v95
    v_smfmac_f32_16x16x64_bf16 v[112:115], v[24:27], v[80:87], v29
    ds_read_b64_tr_b16 v[200:201], v161 offset:64
    ds_read_b64_tr_b16 v[202:203], v161 offset:576
    ds_read_b64_tr_b16 v[204:205], v161 offset:96
    ds_read_b64_tr_b16 v[206:207], v161 offset:608
    v_exp_f32 v64, v64
    s_waitcnt lgkmcnt(7)
    v_smfmac_f32_32x32x32_bf16 v[96:111], v[60:63], v[88:95], v29
    ds_read_b128 v[60:63], v20 offset:3072
    v_exp_f32 v65, v65
    v_exp_f32 v66, v66
    v_exp_f32 v67, v67
    s_waitcnt lgkmcnt(6)
    v_smfmac_f32_16x16x64_bf16 v[112:115], v[24:27], v[88:95], v29
    v_exp_f32 v68, v68
    v_exp_f32 v69, v69
    v_mfma_f32_32x32x16_bf16 v[80:95], v[116:119], v[32:35], v[40:55]
    s_setprio 2
    v_exp_f32 v70, v70
    v_exp_f32 v71, v71
    v_exp_f32 v72, v72
    v_mfma_f32_32x32x16_bf16 v[80:95], v[120:123], v[36:39], v[80:95]
    ds_read_b128 v[116:119], v20 offset:8192
    ds_read_b128 v[120:123], v20 offset:9216
    v_exp_f32 v73, v73
    v_exp_f32 v74, v74
    v_exp_f32 v75, v75
    s_waitcnt lgkmcnt(7)
    v_smfmac_f32_32x32x32_bf16 v[96:111], v[56:59], v[64:71], v29
    ds_read_b128 v[56:59], v20 offset:6144
    s_add_u32 m0, s45, 33792
    s_add_u32 s46, s45, 132096
    buffer_load_dwordx4 v20, s[20:23], s46 offen sc1 lds
    v_exp_f32 v76, v76
    v_exp_f32 v77, v77
    v_exp_f32 v78, v78
    v_exp_f32 v79, v79
    v_smfmac_f32_16x16x64_bf16 v[112:115], v[24:27], v[64:71], v29
    s_waitcnt vmcnt(2)
    ds_read_b64_tr_b16 v[208:209], v161 offset:4096
    ds_read_b64_tr_b16 v[210:211], v161 offset:4608
    ds_read_b64_tr_b16 v[212:213], v161 offset:4128
    ds_read_b64_tr_b16 v[214:215], v161 offset:4640
    v_mfma_f32_16x16x32_bf16 v[224:227], v[176:179], v[192:195], 0
    v_mfma_f32_16x16x32_bf16 v[228:231], v[176:179], v[196:199], 0
    v_exp_f32 v80, v80
    s_waitcnt lgkmcnt(7)
    v_smfmac_f32_32x32x32_bf16 v[96:111], v[60:63], v[72:79], v29
    ds_read_b128 v[60:63], v20 offset:7168
    v_exp_f32 v81, v81
    v_exp_f32 v82, v82
    v_exp_f32 v83, v83
    s_waitcnt lgkmcnt(6)
    v_smfmac_f32_16x16x64_bf16 v[112:115], v[24:27], v[72:79], v29
    v_exp_f32 v84, v84
    v_exp_f32 v85, v85
    v_mfma_f32_32x32x16_bf16 v[64:79], v[116:119], v[32:35], v[40:55]
    s_setprio 1
    v_exp_f32 v86, v86
    v_exp_f32 v87, v87
    v_exp_f32 v88, v88
    v_mfma_f32_32x32x16_bf16 v[64:79], v[120:123], v[36:39], v[64:79]
    ds_read_b128 v[116:119], v20 offset:12288
    ds_read_b128 v[120:123], v20 offset:13312
    v_exp_f32 v89, v89
    v_exp_f32 v90, v90
    v_exp_f32 v91, v91
    s_waitcnt lgkmcnt(7)
    v_smfmac_f32_32x32x32_bf16 v[96:111], v[56:59], v[80:87], v29
    ds_read_b128 v[56:59], v20 offset:10240
    s_add_u32 m0, s45, 34816
    s_add_u32 s46, s45, 133120
    buffer_load_dwordx4 v20, s[20:23], s46 offen sc1 lds
    v_exp_f32 v92, v92
    v_exp_f32 v93, v93
    v_exp_f32 v94, v94
    v_exp_f32 v95, v95
    v_smfmac_f32_16x16x64_bf16 v[112:115], v[24:27], v[80:87], v29
    ds_read_b64_tr_b16 v[216:217], v161 offset:4160
    ds_read_b64_tr_b16 v[218:219], v161 offset:4672
    ds_read_b64_tr_b16 v[220:221], v161 offset:4192
    ds_read_b64_tr_b16 v[222:223], v161 offset:4704
    v_mfma_f32_16x16x32_bf16 v[232:235], v[176:179], v[200:203], 0
    v_mfma_f32_16x16x32_bf16 v[236:239], v[176:179], v[204:207], 0
    v_exp_f32 v64, v64
    s_waitcnt lgkmcnt(7)
    v_smfmac_f32_32x32x32_bf16 v[96:111], v[60:63], v[88:95], v29
    ds_read_b128 v[60:63], v20 offset:11264
    v_exp_f32 v65, v65
    v_exp_f32 v66, v66
    v_exp_f32 v67, v67
    s_waitcnt lgkmcnt(6)
    v_smfmac_f32_16x16x64_bf16 v[112:115], v[24:27], v[88:95], v29
    v_exp_f32 v68, v68
    v_exp_f32 v69, v69
    v_mfma_f32_32x32x16_bf16 v[80:95], v[116:119], v[32:35], v[40:55]
    s_setprio 0
    v_exp_f32 v70, v70
    v_exp_f32 v71, v71
    v_exp_f32 v72, v72
    v_mfma_f32_32x32x16_bf16 v[80:95], v[120:123], v[36:39], v[80:95]
    ds_read_b128 v[116:119], v20 offset:16384
    ds_read_b128 v[120:123], v20 offset:17408
    v_exp_f32 v73, v73
    v_exp_f32 v74, v74
    v_exp_f32 v75, v75
    s_waitcnt lgkmcnt(7)
    v_smfmac_f32_32x32x32_bf16 v[96:111], v[56:59], v[64:71], v29
    ds_read_b128 v[56:59], v20 offset:14336
    s_add_u32 m0, s45, 35840
    s_add_u32 s46, s45, 134144
    buffer_load_dwordx4 v20, s[20:23], s46 offen sc1 lds
    v_exp_f32 v76, v76
    v_exp_f32 v77, v77
    v_exp_f32 v78, v78
    v_exp_f32 v79, v79
    v_smfmac_f32_16x16x64_bf16 v[112:115], v[24:27], v[64:71], v29
    v_mfma_f32_16x16x32_bf16 v[240:243], v[176:179], v[208:211], 0
    v_mfma_f32_16x16x32_bf16 v[244:247], v[176:179], v[212:215], 0
    v_exp_f32 v80, v80
    s_waitcnt lgkmcnt(3)
    v_smfmac_f32_32x32x32_bf16 v[96:111], v[60:63], v[72:79], v29
    ds_read_b128 v[60:63], v20 offset:15360
    v_exp_f32 v81, v81
    v_exp_f32 v82, v82
    v_exp_f32 v83, v83
    s_waitcnt lgkmcnt(2)
    v_smfmac_f32_16x16x64_bf16 v[112:115], v[24:27], v[72:79], v29
    v_exp_f32 v84, v84
    v_exp_f32 v85, v85
    v_mfma_f32_32x32x16_bf16 v[64:79], v[116:119], v[32:35], v[40:55]
    s_setprio 3
    v_exp_f32 v86, v86
    v_exp_f32 v87, v87
    v_exp_f32 v88, v88
    v_mfma_f32_32x32x16_bf16 v[64:79], v[120:123], v[36:39], v[64:79]
    ds_read_b128 v[116:119], v20 offset:20480
    ds_read_b128 v[120:123], v20 offset:21504
    v_exp_f32 v89, v89
    v_exp_f32 v90, v90
    v_exp_f32 v91, v91
    s_waitcnt lgkmcnt(3)
    v_smfmac_f32_32x32x32_bf16 v[96:111], v[56:59], v[80:87], v29
    ds_read_b128 v[56:59], v20 offset:18432
    v_exp_f32 v92, v92
    v_exp_f32 v93, v93
    v_exp_f32 v94, v94
    v_exp_f32 v95, v95
    v_smfmac_f32_16x16x64_bf16 v[112:115], v[24:27], v[80:87], v29
    v_mfma_f32_16x16x32_bf16 v[248:251], v[176:179], v[216:219], 0
    v_mfma_f32_16x16x32_bf16 v[252:255], v[176:179], v[220:223], 0
    v_exp_f32 v64, v64
    s_waitcnt lgkmcnt(3)
    v_smfmac_f32_32x32x32_bf16 v[96:111], v[60:63], v[88:95], v29
    ds_read_b128 v[60:63], v20 offset:19456
    v_exp_f32 v65, v65
    v_exp_f32 v66, v66
    v_exp_f32 v67, v67
    s_waitcnt lgkmcnt(2)
    v_smfmac_f32_16x16x64_bf16 v[112:115], v[24:27], v[88:95], v29
    v_exp_f32 v68, v68
    v_exp_f32 v69, v69
    v_mfma_f32_32x32x16_bf16 v[80:95], v[116:119], v[32:35], v[40:55]
    s_setprio 2
    v_exp_f32 v70, v70
    v_exp_f32 v71, v71
    v_exp_f32 v72, v72
    v_mfma_f32_32x32x16_bf16 v[80:95], v[120:123], v[36:39], v[80:95]
    ds_read_b128 v[116:119], v20 offset:24576
    ds_read_b128 v[120:123], v20 offset:25600
    v_exp_f32 v73, v73
    v_exp_f32 v74, v74
    v_exp_f32 v75, v75
    s_waitcnt lgkmcnt(3)
    v_smfmac_f32_32x32x32_bf16 v[96:111], v[56:59], v[64:71], v29
    ds_read_b128 v[56:59], v20 offset:22528
    v_exp_f32 v76, v76
    v_exp_f32 v77, v77
    v_exp_f32 v78, v78
    v_exp_f32 v79, v79
    v_smfmac_f32_16x16x64_bf16 v[112:115], v[24:27], v[64:71], v29
    v_mov_b32_dpp v224, v228 quad_perm:[0,1,2,3] row_mask:0x2 bank_mask:0xf
    v_mov_b32_dpp v240, v244 quad_perm:[0,1,2,3] row_mask:0x2 bank_mask:0xf
    s_nop 0
    v_mov_b32_dpp v224, v232 quad_perm:[0,1,2,3] row_mask:0x4 bank_mask:0xf
    v_mov_b32_dpp v240, v248 quad_perm:[0,1,2,3] row_mask:0x4 bank_mask:0xf
    s_nop 0
    v_mov_b32_dpp v224, v236 quad_perm:[0,1,2,3] row_mask:0x8 bank_mask:0xf
    v_mov_b32_dpp v240, v252 quad_perm:[0,1,2,3] row_mask:0x8 bank_mask:0xf
    s_add_u32 s39, s65, 14336
    buffer_atomic_add_f32 v224, v165, s[16:19], s65 offen
    buffer_atomic_add_f32 v240, v165, s[16:19], s39 offen
    s_add_u32 m0, s66, 0
    s_add_u32 s39, s94, 0
    buffer_load_dwordx4 v162, s[12:15], s39 offen lds
    v_exp_f32 v80, v80
    s_waitcnt lgkmcnt(3)
    v_smfmac_f32_32x32x32_bf16 v[96:111], v[60:63], v[72:79], v29
    ds_read_b128 v[60:63], v20 offset:23552
    v_exp_f32 v81, v81
    v_exp_f32 v82, v82
    v_exp_f32 v83, v83
    s_waitcnt lgkmcnt(2)
    v_smfmac_f32_16x16x64_bf16 v[112:115], v[24:27], v[72:79], v29
    v_exp_f32 v84, v84
    v_exp_f32 v85, v85
    v_mfma_f32_32x32x16_bf16 v[64:79], v[116:119], v[32:35], v[40:55]
    s_setprio 1
    v_exp_f32 v86, v86
    v_exp_f32 v87, v87
    v_exp_f32 v88, v88
    v_mfma_f32_32x32x16_bf16 v[64:79], v[120:123], v[36:39], v[64:79]
    ds_read_b128 v[116:119], v20 offset:28672
    ds_read_b128 v[120:123], v20 offset:29696
    v_exp_f32 v89, v89
    v_exp_f32 v90, v90
    v_exp_f32 v91, v91
    s_waitcnt lgkmcnt(3)
    v_smfmac_f32_32x32x32_bf16 v[96:111], v[56:59], v[80:87], v29
    ds_read_b128 v[56:59], v20 offset:26624
    v_exp_f32 v92, v92
    v_exp_f32 v93, v93
    v_exp_f32 v94, v94
    v_exp_f32 v95, v95
    v_smfmac_f32_16x16x64_bf16 v[112:115], v[24:27], v[80:87], v29
    v_exp_f32 v64, v64
    s_waitcnt lgkmcnt(3)
    v_smfmac_f32_32x32x32_bf16 v[96:111], v[60:63], v[88:95], v29
    ds_read_b128 v[60:63], v20 offset:27648
    v_exp_f32 v65, v65
    v_exp_f32 v66, v66
    v_exp_f32 v67, v67
    s_waitcnt lgkmcnt(2)
    v_smfmac_f32_16x16x64_bf16 v[112:115], v[24:27], v[88:95], v29
    v_exp_f32 v68, v68
    v_exp_f32 v69, v69
    v_mfma_f32_32x32x16_bf16 v[80:95], v[116:119], v[32:35], v[40:55]
    s_setprio 0
    v_exp_f32 v70, v70
    v_exp_f32 v71, v71
    v_exp_f32 v72, v72
    v_mfma_f32_32x32x16_bf16 v[80:95], v[120:123], v[36:39], v[80:95]
    s_waitcnt vmcnt(3)
    s_barrier
    ds_read_b128 v[116:119], v20 offset:32768
    ds_read_b128 v[120:123], v20 offset:33792
    v_exp_f32 v73, v73
    v_exp_f32 v74, v74
    v_exp_f32 v75, v75
    s_waitcnt lgkmcnt(3)
    v_smfmac_f32_32x32x32_bf16 v[96:111], v[56:59], v[64:71], v29
    ds_read_b128 v[56:59], v20 offset:30720
    v_exp_f32 v76, v76
    v_exp_f32 v77, v77
    v_exp_f32 v78, v78
    v_exp_f32 v79, v79
    v_smfmac_f32_16x16x64_bf16 v[112:115], v[24:27], v[64:71], v29
    s_add_u32 m0, s66, 1024
    s_add_u32 s39, s94, 8192
    buffer_load_dwordx4 v162, s[12:15], s39 offen lds
    v_exp_f32 v80, v80
    s_waitcnt lgkmcnt(3)
    v_smfmac_f32_32x32x32_bf16 v[96:111], v[60:63], v[72:79], v29
    ds_read_b128 v[60:63], v20 offset:31744
    v_exp_f32 v81, v81
    v_exp_f32 v82, v82
    v_exp_f32 v83, v83
    s_waitcnt lgkmcnt(2)
    v_smfmac_f32_16x16x64_bf16 v[112:115], v[24:27], v[72:79], v29
    v_exp_f32 v84, v84
    v_exp_f32 v85, v85
    v_mfma_f32_32x32x16_bf16 v[64:79], v[116:119], v[32:35], v[40:55]
    s_setprio 3
    v_exp_f32 v86, v86
    v_exp_f32 v87, v87
    v_exp_f32 v88, v88
    v_mfma_f32_32x32x16_bf16 v[64:79], v[120:123], v[36:39], v[64:79]
    ds_read_b128 v[116:119], v20 offset:36864
    ds_read_b128 v[120:123], v20 offset:37888
    v_exp_f32 v89, v89
    v_exp_f32 v90, v90
    v_exp_f32 v91, v91
    s_waitcnt lgkmcnt(3)
    v_smfmac_f32_32x32x32_bf16 v[96:111], v[56:59], v[80:87], v29
    ds_read_b128 v[56:59], v20 offset:34816
    s_add_u32 m0, s45, 65536
    s_add_u32 s46, s45, 163840
    buffer_load_dwordx4 v20, s[20:23], s46 offen sc1 lds
    v_exp_f32 v92, v92
    v_exp_f32 v93, v93
    v_exp_f32 v94, v94
    v_exp_f32 v95, v95
    v_smfmac_f32_16x16x64_bf16 v[112:115], v[24:27], v[80:87], v29
    v_exp_f32 v64, v64
    s_waitcnt lgkmcnt(3)
    v_smfmac_f32_32x32x32_bf16 v[96:111], v[60:63], v[88:95], v29
    ds_read_b128 v[60:63], v20 offset:35840
    v_exp_f32 v65, v65
    v_exp_f32 v66, v66
    v_exp_f32 v67, v67
    s_waitcnt lgkmcnt(2)
    v_smfmac_f32_16x16x64_bf16 v[112:115], v[24:27], v[88:95], v29
    v_exp_f32 v68, v68
    v_exp_f32 v69, v69
    v_mfma_f32_32x32x16_bf16 v[80:95], v[116:119], v[32:35], v[40:55]
    s_setprio 2
    v_exp_f32 v70, v70
    v_exp_f32 v71, v71
    v_exp_f32 v72, v72
    v_mfma_f32_32x32x16_bf16 v[80:95], v[120:123], v[36:39], v[80:95]
    ds_read_b128 v[116:119], v20 offset:40960
    ds_read_b128 v[120:123], v20 offset:41984
    v_exp_f32 v73, v73
    v_exp_f32 v74, v74
    v_exp_f32 v75, v75
    s_waitcnt lgkmcnt(3)
    v_smfmac_f32_32x32x32_bf16 v[96:111], v[56:59], v[64:71], v29
    ds_read_b128 v[56:59], v20 offset:38912
    s_add_u32 m0, s45, 66560
    s_add_u32 s46, s45, 164864
    buffer_load_dwordx4 v20, s[20:23], s46 offen sc1 lds
    v_exp_f32 v76, v76
    v_exp_f32 v77, v77
    v_exp_f32 v78, v78
    v_exp_f32 v79, v79
    v_smfmac_f32_16x16x64_bf16 v[112:115], v[24:27], v[64:71], v29
    v_exp_f32 v80, v80
    s_waitcnt lgkmcnt(3)
    v_smfmac_f32_32x32x32_bf16 v[96:111], v[60:63], v[72:79], v29
    ds_read_b128 v[60:63], v20 offset:39936
    v_exp_f32 v81, v81
    v_exp_f32 v82, v82
    v_exp_f32 v83, v83
    s_waitcnt lgkmcnt(2)
    v_smfmac_f32_16x16x64_bf16 v[112:115], v[24:27], v[72:79], v29
    v_exp_f32 v84, v84
    v_exp_f32 v85, v85
    v_mfma_f32_32x32x16_bf16 v[64:79], v[116:119], v[32:35], v[40:55]
    s_setprio 1
    v_exp_f32 v86, v86
    v_exp_f32 v87, v87
    v_exp_f32 v88, v88
    v_mfma_f32_32x32x16_bf16 v[64:79], v[120:123], v[36:39], v[64:79]
    ds_read_b128 v[116:119], v20 offset:45056
    ds_read_b128 v[120:123], v20 offset:46080
    v_exp_f32 v89, v89
    v_exp_f32 v90, v90
    v_exp_f32 v91, v91
    s_waitcnt lgkmcnt(3)
    v_smfmac_f32_32x32x32_bf16 v[96:111], v[56:59], v[80:87], v29
    ds_read_b128 v[56:59], v20 offset:43008
    s_add_u32 m0, s45, 67584
    s_add_u32 s46, s45, 165888
    buffer_load_dwordx4 v20, s[20:23], s46 offen sc1 lds
    v_exp_f32 v92, v92
    v_exp_f32 v93, v93
    v_exp_f32 v94, v94
    v_exp_f32 v95, v95
    v_smfmac_f32_16x16x64_bf16 v[112:115], v[24:27], v[80:87], v29
    v_exp_f32 v64, v64
    s_waitcnt lgkmcnt(3)
    v_smfmac_f32_32x32x32_bf16 v[96:111], v[60:63], v[88:95], v29
    ds_read_b128 v[60:63], v20 offset:44032
    v_exp_f32 v65, v65
    v_exp_f32 v66, v66
    v_exp_f32 v67, v67
    s_waitcnt lgkmcnt(2)
    v_smfmac_f32_16x16x64_bf16 v[112:115], v[24:27], v[88:95], v29
    v_exp_f32 v68, v68
    v_exp_f32 v69, v69
    v_mfma_f32_32x32x16_bf16 v[80:95], v[116:119], v[32:35], v[40:55]
    s_setprio 0
    v_exp_f32 v70, v70
    v_exp_f32 v71, v71
    v_exp_f32 v72, v72
    v_mfma_f32_32x32x16_bf16 v[80:95], v[120:123], v[36:39], v[80:95]
    ds_read_b128 v[116:119], v20 offset:49152
    ds_read_b128 v[120:123], v20 offset:50176
    v_exp_f32 v73, v73
    v_exp_f32 v74, v74
    v_exp_f32 v75, v75
    s_waitcnt lgkmcnt(3)
    v_smfmac_f32_32x32x32_bf16 v[96:111], v[56:59], v[64:71], v29
    ds_read_b128 v[56:59], v20 offset:47104
    s_add_u32 m0, s45, 68608
    s_add_u32 s46, s45, 166912
    buffer_load_dwordx4 v20, s[20:23], s46 offen sc1 lds
    v_exp_f32 v76, v76
    v_exp_f32 v77, v77
    v_exp_f32 v78, v78
    v_exp_f32 v79, v79
    v_smfmac_f32_16x16x64_bf16 v[112:115], v[24:27], v[64:71], v29
    s_add_u32 m0, s66, 2048
    s_add_u32 s39, s94, 16384
    buffer_load_dwordx4 v162, s[12:15], s39 offen lds
    v_exp_f32 v80, v80
    s_waitcnt lgkmcnt(3)
    v_smfmac_f32_32x32x32_bf16 v[96:111], v[60:63], v[72:79], v29
    ds_read_b128 v[60:63], v20 offset:48128
    v_exp_f32 v81, v81
    v_exp_f32 v82, v82
    v_exp_f32 v83, v83
    s_waitcnt lgkmcnt(2)
    v_smfmac_f32_16x16x64_bf16 v[112:115], v[24:27], v[72:79], v29
    v_exp_f32 v84, v84
    v_exp_f32 v85, v85
    v_mfma_f32_32x32x16_bf16 v[64:79], v[116:119], v[32:35], v[40:55]
    s_setprio 3
    v_exp_f32 v86, v86
    v_exp_f32 v87, v87
    v_exp_f32 v88, v88
    v_mfma_f32_32x32x16_bf16 v[64:79], v[120:123], v[36:39], v[64:79]
    ds_read_b128 v[116:119], v20 offset:53248
    ds_read_b128 v[120:123], v20 offset:54272
    v_exp_f32 v89, v89
    v_exp_f32 v90, v90
    v_exp_f32 v91, v91
    s_waitcnt lgkmcnt(3)
    v_smfmac_f32_32x32x32_bf16 v[96:111], v[56:59], v[80:87], v29
    ds_read_b128 v[56:59], v20 offset:51200
    v_exp_f32 v92, v92
    v_exp_f32 v93, v93
    v_exp_f32 v94, v94
    v_exp_f32 v95, v95
    v_smfmac_f32_16x16x64_bf16 v[112:115], v[24:27], v[80:87], v29
    s_waitcnt vmcnt(7)
    s_lshr_b32 s67, s56, 2
    s_lshl_b32 s67, s67, 7
    s_add_u32 s67, s67, 0x6a000
    s_cmp_lt_u32 s2, 224
    s_cselect_b32 s67, s67, 0x40000000
    v_mov_b32 v174, 1
    s_mov_b64 exec, 1
    buffer_atomic_add v174, v165, s[16:19], s67 offen sc1
    s_mov_b64 exec, -1
    v_exp_f32 v64, v64
    s_waitcnt lgkmcnt(3)
    v_smfmac_f32_32x32x32_bf16 v[96:111], v[60:63], v[88:95], v29
    ds_read_b128 v[60:63], v20 offset:52224
    v_exp_f32 v65, v65
    v_exp_f32 v66, v66
    v_exp_f32 v67, v67
    s_waitcnt lgkmcnt(2)
    v_smfmac_f32_16x16x64_bf16 v[112:115], v[24:27], v[88:95], v29
    v_exp_f32 v68, v68
    v_exp_f32 v69, v69
    v_mfma_f32_32x32x16_bf16 v[80:95], v[116:119], v[32:35], v[40:55]
    s_setprio 2
    v_exp_f32 v70, v70
    v_exp_f32 v71, v71
    v_exp_f32 v72, v72
    v_mfma_f32_32x32x16_bf16 v[80:95], v[120:123], v[36:39], v[80:95]
    ds_read_b128 v[116:119], v20 offset:57344
    ds_read_b128 v[120:123], v20 offset:58368
    v_exp_f32 v73, v73
    v_exp_f32 v74, v74
    v_exp_f32 v75, v75
    s_waitcnt lgkmcnt(3)
    v_smfmac_f32_32x32x32_bf16 v[96:111], v[56:59], v[64:71], v29
    ds_read_b128 v[56:59], v20 offset:55296
    v_exp_f32 v76, v76
    v_exp_f32 v77, v77
    v_exp_f32 v78, v78
    v_exp_f32 v79, v79
    v_smfmac_f32_16x16x64_bf16 v[112:115], v[24:27], v[64:71], v29
    s_add_u32 m0, s66, 3072
    s_add_u32 s39, s94, 24576
    buffer_load_dwordx4 v162, s[12:15], s39 offen lds
    v_exp_f32 v80, v80
    s_waitcnt lgkmcnt(3)
    v_smfmac_f32_32x32x32_bf16 v[96:111], v[60:63], v[72:79], v29
    ds_read_b128 v[60:63], v20 offset:56320
    v_exp_f32 v81, v81
    v_exp_f32 v82, v82
    v_exp_f32 v83, v83
    s_waitcnt lgkmcnt(2)
    v_smfmac_f32_16x16x64_bf16 v[112:115], v[24:27], v[72:79], v29
    v_exp_f32 v84, v84
    v_exp_f32 v85, v85
    v_mfma_f32_32x32x16_bf16 v[64:79], v[116:119], v[32:35], v[40:55]
    s_setprio 1
    v_exp_f32 v86, v86
    v_exp_f32 v87, v87
    v_exp_f32 v88, v88
    v_mfma_f32_32x32x16_bf16 v[64:79], v[120:123], v[36:39], v[64:79]
    ds_read_b128 v[116:119], v20 offset:61440
    ds_read_b128 v[120:123], v20 offset:62464
    v_exp_f32 v89, v89
    v_exp_f32 v90, v90
    v_exp_f32 v91, v91
    s_waitcnt lgkmcnt(3)
    v_smfmac_f32_32x32x32_bf16 v[96:111], v[56:59], v[80:87], v29
    ds_read_b128 v[56:59], v20 offset:59392
    v_exp_f32 v92, v92
    v_exp_f32 v93, v93
    v_exp_f32 v94, v94
    v_exp_f32 v95, v95
    v_smfmac_f32_16x16x64_bf16 v[112:115], v[24:27], v[80:87], v29
    v_exp_f32 v64, v64
    s_waitcnt lgkmcnt(3)
    v_smfmac_f32_32x32x32_bf16 v[96:111], v[60:63], v[88:95], v29
    ds_read_b128 v[60:63], v20 offset:60416
    v_exp_f32 v65, v65
    v_exp_f32 v66, v66
    v_exp_f32 v67, v67
    s_waitcnt lgkmcnt(2)
    v_smfmac_f32_16x16x64_bf16 v[112:115], v[24:27], v[88:95], v29
    v_exp_f32 v68, v68
    v_exp_f32 v69, v69
    v_mfma_f32_32x32x16_bf16 v[80:95], v[116:119], v[32:35], v[40:55]
    s_setprio 0
    v_exp_f32 v70, v70
    v_exp_f32 v71, v71
    v_exp_f32 v72, v72
    v_mfma_f32_32x32x16_bf16 v[80:95], v[120:123], v[36:39], v[80:95]
    s_waitcnt vmcnt(3)
    s_barrier
    ds_read_b128 v[116:119], v17 offset:0
    ds_read_b128 v[120:123], v17 offset:1024
    v_exp_f32 v73, v73
    v_exp_f32 v74, v74
    v_exp_f32 v75, v75
    s_waitcnt lgkmcnt(3)
    v_smfmac_f32_32x32x32_bf16 v[96:111], v[56:59], v[64:71], v29
    ds_read_b128 v[56:59], v20 offset:63488
    v_exp_f32 v76, v76
    v_exp_f32 v77, v77
    v_exp_f32 v78, v78
    v_exp_f32 v79, v79
    v_smfmac_f32_16x16x64_bf16 v[112:115], v[24:27], v[64:71], v29
    v_exp_f32 v80, v80
    s_waitcnt lgkmcnt(3)
    v_smfmac_f32_32x32x32_bf16 v[96:111], v[60:63], v[72:79], v29
    ds_read_b128 v[60:63], v20 offset:64512
    v_exp_f32 v81, v81
    v_exp_f32 v82, v82
    v_exp_f32 v83, v83
    s_waitcnt lgkmcnt(2)
    v_smfmac_f32_16x16x64_bf16 v[112:115], v[24:27], v[72:79], v29
    v_exp_f32 v84, v84
    v_exp_f32 v85, v85
    v_mfma_f32_32x32x16_bf16 v[64:79], v[116:119], v[32:35], v[40:55]
    s_setprio 3
    v_exp_f32 v86, v86
    v_exp_f32 v87, v87
    v_exp_f32 v88, v88
    v_mfma_f32_32x32x16_bf16 v[64:79], v[120:123], v[36:39], v[64:79]
    ds_read_b128 v[116:119], v17 offset:4096
    ds_read_b128 v[120:123], v17 offset:5120
    v_exp_f32 v89, v89
    v_exp_f32 v90, v90
    v_exp_f32 v91, v91
    s_waitcnt lgkmcnt(3)
    v_smfmac_f32_32x32x32_bf16 v[96:111], v[56:59], v[80:87], v29
    ds_read_b128 v[56:59], v17 offset:2048
    s_add_u32 m0, s45, 0
    s_add_u32 s46, s45, 196608
    buffer_load_dwordx4 v20, s[20:23], s46 offen sc1 lds
    v_exp_f32 v92, v92
    v_exp_f32 v93, v93
    v_exp_f32 v94, v94
    v_exp_f32 v95, v95
    v_smfmac_f32_16x16x64_bf16 v[112:115], v[24:27], v[80:87], v29
    v_exp_f32 v64, v64
    s_waitcnt lgkmcnt(3)
    v_smfmac_f32_32x32x32_bf16 v[96:111], v[60:63], v[88:95], v29
    ds_read_b128 v[60:63], v17 offset:3072
    v_exp_f32 v65, v65
    v_exp_f32 v66, v66
    v_exp_f32 v67, v67
    s_waitcnt lgkmcnt(2)
    v_smfmac_f32_16x16x64_bf16 v[112:115], v[24:27], v[88:95], v29
    v_exp_f32 v68, v68
    v_exp_f32 v69, v69
    v_mfma_f32_32x32x16_bf16 v[80:95], v[116:119], v[32:35], v[40:55]
    s_setprio 2
    v_exp_f32 v70, v70
    v_exp_f32 v71, v71
    v_exp_f32 v72, v72
    v_mfma_f32_32x32x16_bf16 v[80:95], v[120:123], v[36:39], v[80:95]
    ds_read_b128 v[116:119], v17 offset:8192
    ds_read_b128 v[120:123], v17 offset:9216
    v_exp_f32 v73, v73
    v_exp_f32 v74, v74
    v_exp_f32 v75, v75
    s_waitcnt lgkmcnt(3)
    v_smfmac_f32_32x32x32_bf16 v[96:111], v[56:59], v[64:71], v29
    ds_read_b128 v[56:59], v17 offset:6144
    s_add_u32 m0, s45, 1024
    s_add_u32 s46, s45, 197632
    buffer_load_dwordx4 v20, s[20:23], s46 offen sc1 lds
    v_exp_f32 v76, v76
    v_exp_f32 v77, v77
    v_exp_f32 v78, v78
    v_exp_f32 v79, v79
    v_smfmac_f32_16x16x64_bf16 v[112:115], v[24:27], v[64:71], v29
    s_lshl_b32 s61, s3, 8
    s_add_u32 s61, s61, s2
    v_mov_b32 v168, 0
    s_cmp_lt_u32 s61, 224
    s_cbranch_scc0 L_51
    buffer_load_dword v169, v168, s[16:19], s67 offen sc1
L_51:
    v_exp_f32 v80, v80
    s_waitcnt lgkmcnt(3)
    v_smfmac_f32_32x32x32_bf16 v[96:111], v[60:63], v[72:79], v29
    ds_read_b128 v[60:63], v17 offset:7168
    v_exp_f32 v81, v81
    v_exp_f32 v82, v82
    v_exp_f32 v83, v83
    s_waitcnt lgkmcnt(2)
    v_smfmac_f32_16x16x64_bf16 v[112:115], v[24:27], v[72:79], v29
    v_exp_f32 v84, v84
    v_exp_f32 v85, v85
    v_mfma_f32_32x32x16_bf16 v[64:79], v[116:119], v[32:35], v[40:55]
    s_setprio 1
    v_exp_f32 v86, v86
    v_exp_f32 v87, v87
    v_exp_f32 v88, v88
    v_mfma_f32_32x32x16_bf16 v[64:79], v[120:123], v[36:39], v[64:79]
    ds_read_b128 v[116:119], v17 offset:12288
    ds_read_b128 v[120:123], v17 offset:13312
    v_exp_f32 v89, v89
    v_exp_f32 v90, v90
    v_exp_f32 v91, v91
    s_waitcnt lgkmcnt(3)
    v_smfmac_f32_32x32x32_bf16 v[96:111], v[56:59], v[80:87], v29
    ds_read_b128 v[56:59], v17 offset:10240
    s_add_u32 m0, s45, 2048
    s_add_u32 s46, s45, 198656
    buffer_load_dwordx4 v20, s[20:23], s46 offen sc1 lds
    v_exp_f32 v92, v92
    v_exp_f32 v93, v93
    v_exp_f32 v94, v94
    v_exp_f32 v95, v95
    v_smfmac_f32_16x16x64_bf16 v[112:115], v[24:27], v[80:87], v29
    v_exp_f32 v64, v64
    s_waitcnt lgkmcnt(3)
    v_smfmac_f32_32x32x32_bf16 v[96:111], v[60:63], v[88:95], v29
    ds_read_b128 v[60:63], v17 offset:11264
    v_exp_f32 v65, v65
    v_exp_f32 v66, v66
    v_exp_f32 v67, v67
    s_waitcnt lgkmcnt(2)
    v_smfmac_f32_16x16x64_bf16 v[112:115], v[24:27], v[88:95], v29
    v_exp_f32 v68, v68
    v_exp_f32 v69, v69
    v_mfma_f32_32x32x16_bf16 v[80:95], v[116:119], v[32:35], v[40:55]
    s_setprio 0
    v_exp_f32 v70, v70
    v_exp_f32 v71, v71
    v_exp_f32 v72, v72
    v_mfma_f32_32x32x16_bf16 v[80:95], v[120:123], v[36:39], v[80:95]
    ds_read_b128 v[116:119], v17 offset:16384
    ds_read_b128 v[120:123], v17 offset:17408
    v_exp_f32 v73, v73
    v_exp_f32 v74, v74
    v_exp_f32 v75, v75
    s_waitcnt lgkmcnt(3)
    v_smfmac_f32_32x32x32_bf16 v[96:111], v[56:59], v[64:71], v29
    ds_read_b128 v[56:59], v17 offset:14336
    s_add_u32 m0, s45, 3072
    s_add_u32 s46, s45, 199680
    buffer_load_dwordx4 v20, s[20:23], s46 offen sc1 lds
    v_exp_f32 v76, v76
    v_exp_f32 v77, v77
    v_exp_f32 v78, v78
    v_exp_f32 v79, v79
    v_smfmac_f32_16x16x64_bf16 v[112:115], v[24:27], v[64:71], v29
    s_cmp_lt_u32 s61, 224
    s_cbranch_scc0 L_52
    s_waitcnt vmcnt(2)
    s_mov_b32 s42, 0
    s_branch pchk_54
poll_53:
    buffer_load_dword v169, v168, s[16:19], s67 offen sc1
    s_waitcnt vmcnt(0)
pchk_54:
    v_cmp_ne_u32 vcc, 32, v169
    s_add_u32 s42, s42, 1
    s_cbranch_vccz pdone_55
    s_sleep 2
    s_cmp_lt_u32 s42, 200000
    s_cbranch_scc1 poll_53
pdone_55:
    v_and_b32 v168, 60, v165
    v_bfe_u32 v169, v2, 4, 1
    v_mul_u32_u24 v169, 14336, v169
    v_add_u32 v169, v169, v168
    s_lshl_b32 s39, s56, 6
    s_add_u32 s39, s39, 0x58000
    buffer_load_dword v224, v169, s[16:19], s39 offen sc1
L_52:
    v_exp_f32 v80, v80
    s_waitcnt lgkmcnt(3)
    v_smfmac_f32_32x32x32_bf16 v[96:111], v[60:63], v[72:79], v29
    ds_read_b128 v[60:63], v17 offset:15360
    v_exp_f32 v81, v81
    v_exp_f32 v82, v82
    v_exp_f32 v83, v83
    s_waitcnt lgkmcnt(2)
    v_smfmac_f32_16x16x64_bf16 v[112:115], v[24:27], v[72:79], v29
    v_exp_f32 v84, v84
    v_exp_f32 v85, v85
    v_mfma_f32_32x32x16_bf16 v[64:79], v[116:119], v[32:35], v[40:55]
    s_setprio 3
    v_exp_f32 v86, v86
    v_exp_f32 v87, v87
    v_exp_f32 v88, v88
    v_mfma_f32_32x32x16_bf16 v[64:79], v[120:123], v[36:39], v[64:79]
    ds_read_b128 v[116:119], v17 offset:20480
    ds_read_b128 v[120:123], v17 offset:21504
    v_exp_f32 v89, v89
    v_exp_f32 v90, v90
    v_exp_f32 v91, v91
    s_waitcnt lgkmcnt(3)
    v_smfmac_f32_32x32x32_bf16 v[96:111], v[56:59], v[80:87], v29
    ds_read_b128 v[56:59], v17 offset:18432
    v_exp_f32 v92, v92
    v_exp_f32 v93, v93
    v_exp_f32 v94, v94
    v_exp_f32 v95, v95
    v_smfmac_f32_16x16x64_bf16 v[112:115], v[24:27], v[80:87], v29
    s_waitcnt vmcnt(4)
    ds_read_b64_tr_b16 v[176:177], v163 offset:0
    ds_read_b64_tr_b16 v[178:179], v163 offset:1024
    v_xor_b32 v173, 64, v163
    ds_read_b64_tr_b16 v[180:181], v173 offset:0
    ds_read_b64_tr_b16 v[182:183], v173 offset:1024
    v_exp_f32 v64, v64
    s_waitcnt lgkmcnt(7)
    v_smfmac_f32_32x32x32_bf16 v[96:111], v[60:63], v[88:95], v29
    ds_read_b128 v[60:63], v17 offset:19456
    v_exp_f32 v65, v65
    v_exp_f32 v66, v66
    v_exp_f32 v67, v67
    s_waitcnt lgkmcnt(6)
    v_smfmac_f32_16x16x64_bf16 v[112:115], v[24:27], v[88:95], v29
    v_exp_f32 v68, v68
    v_exp_f32 v69, v69
    v_mfma_f32_32x32x16_bf16 v[80:95], v[116:119], v[32:35], v[40:55]
    s_setprio 2
    v_exp_f32 v70, v70
    v_exp_f32 v71, v71
    v_exp_f32 v72, v72
    v_mfma_f32_32x32x16_bf16 v[80:95], v[120:123], v[36:39], v[80:95]
    ds_read_b128 v[116:119], v17 offset:24576
    ds_read_b128 v[120:123], v17 offset:25600
    v_exp_f32 v73, v73
    v_exp_f32 v74, v74
    v_exp_f32 v75, v75
    s_waitcnt lgkmcnt(7)
    v_smfmac_f32_32x32x32_bf16 v[96:111], v[56:59], v[64:71], v29
    ds_read_b128 v[56:59], v17 offset:22528
    v_exp_f32 v76, v76
    v_exp_f32 v77, v77
    v_exp_f32 v78, v78
    v_exp_f32 v79, v79
    v_smfmac_f32_16x16x64_bf16 v[112:115], v[24:27], v[64:71], v29
    v_xor_b32 v174, 128, v163
    ds_read_b64_tr_b16 v[184:185], v174 offset:0
    ds_read_b64_tr_b16 v[186:187], v174 offset:1024
    v_xor_b32 v175, 192, v163
    ds_read_b64_tr_b16 v[188:189], v175 offset:0
    ds_read_b64_tr_b16 v[190:191], v175 offset:1024
    s_lshr_b32 s39, s2, 3
    s_lshl_b32 s39, s39, 16
    v_lshlrev_b32 v16, 7, v0
    buffer_load_dword v8, v16, s[8:11], s39 offen
    v_exp_f32 v80, v80
    s_waitcnt lgkmcnt(7)
    v_smfmac_f32_32x32x32_bf16 v[96:111], v[60:63], v[72:79], v29
    ds_read_b128 v[60:63], v17 offset:23552
    v_exp_f32 v81, v81
    v_exp_f32 v82, v82
    v_exp_f32 v83, v83
    s_waitcnt lgkmcnt(6)
    v_smfmac_f32_16x16x64_bf16 v[112:115], v[24:27], v[72:79], v29
    v_exp_f32 v84, v84
    v_exp_f32 v85, v85
    v_mfma_f32_32x32x16_bf16 v[64:79], v[116:119], v[32:35], v[40:55]
    s_setprio 1
    v_exp_f32 v86, v86
    v_exp_f32 v87, v87
    v_exp_f32 v88, v88
    v_mfma_f32_32x32x16_bf16 v[64:79], v[120:123], v[36:39], v[64:79]
    ds_read_b128 v[116:119], v17 offset:28672
    ds_read_b128 v[120:123], v17 offset:29696
    v_exp_f32 v89, v89
    v_exp_f32 v90, v90
    v_exp_f32 v91, v91
    s_waitcnt lgkmcnt(7)
    v_smfmac_f32_32x32x32_bf16 v[96:111], v[56:59], v[80:87], v29
    ds_read_b128 v[56:59], v17 offset:26624
    v_exp_f32 v92, v92
    v_exp_f32 v93, v93
    v_exp_f32 v94, v94
    v_exp_f32 v95, v95
    v_smfmac_f32_16x16x64_bf16 v[112:115], v[24:27], v[80:87], v29
    s_cmp_lt_u32 s61, 224
    s_cbranch_scc0 L_56
    s_waitcnt vmcnt(1)
    v_cvt_pk_bf16_f32 v224, v224, v224
    v_lshlrev_b32 v224, 16, v224
    v_mov_b32 v225, v224
    s_nop 1
    v_permlane16_swap_b32 v224, v225
    v_mul_f32 v226, 0xbfb8aa3b, v224
    v_exp_f32 v226, v226
    s_nop 0
    v_add_f32 v226, 1.0, v226
    v_rcp_f32 v226, v226
    s_nop 0
    v_mul_f32 v224, v224, v226
    v_cvt_pk_bf16_f32 v224, v224, v224
    v_lshlrev_b32 v224, 16, v224
    v_mul_f32 v224, v224, v225
    v_cvt_pk_bf16_f32 v224, v224, v224
    v_lshrrev_b32 v168, 1, v168
    v_add_u32 v168, 102400, v168
    ds_write_b16 v168, v224
    s_waitcnt lgkmcnt(0)
L_56:
    v_exp_f32 v64, v64
    s_waitcnt lgkmcnt(3)
    v_smfmac_f32_32x32x32_bf16 v[96:111], v[60:63], v[88:95], v29
    ds_read_b128 v[60:63], v17 offset:27648
    v_exp_f32 v65, v65
    v_exp_f32 v66, v66
    v_exp_f32 v67, v67
    s_waitcnt lgkmcnt(2)
    v_smfmac_f32_16x16x64_bf16 v[112:115], v[24:27], v[88:95], v29
    v_exp_f32 v68, v68
    v_exp_f32 v69, v69
    v_mfma_f32_32x32x16_bf16 v[80:95], v[116:119], v[32:35], v[40:55]
    s_setprio 0
    v_exp_f32 v70, v70
    v_exp_f32 v71, v71
    v_exp_f32 v72, v72
    v_mfma_f32_32x32x16_bf16 v[80:95], v[120:123], v[36:39], v[80:95]
    s_waitcnt vmcnt(1)
    s_barrier
    ds_read_b128 v[116:119], v20 offset:0
    ds_read_b128 v[120:123], v20 offset:1024
    v_exp_f32 v73, v73
    v_exp_f32 v74, v74
    v_exp_f32 v75, v75
    s_waitcnt lgkmcnt(3)
    v_smfmac_f32_32x32x32_bf16 v[96:111], v[56:59], v[64:71], v29
    ds_read_b128 v[56:59], v17 offset:30720
    v_exp_f32 v76, v76
    v_exp_f32 v77, v77
    v_exp_f32 v78, v78
    v_exp_f32 v79, v79
    v_smfmac_f32_16x16x64_bf16 v[112:115], v[24:27], v[64:71], v29
    v_lshlrev_b32 v172, 4, v4
    v_add_u32 v172, 102400, v172
    ds_read_b128 v[168:171], v172
    v_exp_f32 v80, v80
    s_waitcnt lgkmcnt(4)
    v_smfmac_f32_32x32x32_bf16 v[96:111], v[60:63], v[72:79], v29
    ds_read_b128 v[60:63], v17 offset:31744
    v_exp_f32 v81, v81
    v_exp_f32 v82, v82
    v_exp_f32 v83, v83
    s_waitcnt lgkmcnt(3)
    v_smfmac_f32_16x16x64_bf16 v[112:115], v[24:27], v[72:79], v29
    v_exp_f32 v84, v84
    v_exp_f32 v85, v85
    v_mfma_f32_32x32x16_bf16 v[64:79], v[116:119], v[32:35], v[40:55]
    s_setprio 3
    v_exp_f32 v86, v86
    v_exp_f32 v87, v87
    v_exp_f32 v88, v88
    v_mfma_f32_32x32x16_bf16 v[64:79], v[120:123], v[36:39], v[64:79]
    ds_read_b128 v[116:119], v20 offset:4096
    ds_read_b128 v[120:123], v20 offset:5120
    v_exp_f32 v89, v89
    v_exp_f32 v90, v90
    v_exp_f32 v91, v91
    s_waitcnt lgkmcnt(4)
    v_smfmac_f32_32x32x32_bf16 v[96:111], v[56:59], v[80:87], v29
    ds_read_b128 v[56:59], v20 offset:2048
    s_add_u32 m0, s45, 32768
    s_add_u32 s46, s45, 229376
    buffer_load_dwordx4 v20, s[20:23], s46 offen sc1 lds
    v_exp_f32 v92, v92
    v_exp_f32 v93, v93
    v_exp_f32 v94, v94
    v_exp_f32 v95, v95
    v_smfmac_f32_16x16x64_bf16 v[112:115], v[24:27], v[80:87], v29
    s_waitcnt lgkmcnt(4)
    v_mfma_f32_32x32x16_bf16 v[192:207], v[168:171], v[176:179], 0
    v_exp_f32 v64, v64
    s_waitcnt lgkmcnt(3)
    v_smfmac_f32_32x32x32_bf16 v[96:111], v[60:63], v[88:95], v29
    ds_read_b128 v[60:63], v20 offset:3072
    v_exp_f32 v65, v65
    v_exp_f32 v66, v66
    v_exp_f32 v67, v67
    s_waitcnt lgkmcnt(2)
    v_smfmac_f32_16x16x64_bf16 v[112:115], v[24:27], v[88:95], v29
    v_exp_f32 v68, v68
    v_exp_f32 v69, v69
    v_mfma_f32_32x32x16_bf16 v[80:95], v[116:119], v[32:35], v[40:55]
    s_setprio 2
    v_exp_f32 v70, v70
    v_exp_f32 v71, v71
    v_exp_f32 v72, v72
    v_mfma_f32_32x32x16_bf16 v[80:95], v[120:123], v[36:39], v[80:95]
    ds_read_b128 v[116:119], v20 offset:8192
    ds_read_b128 v[120:123], v20 offset:9216
    v_exp_f32 v73, v73
    v_exp_f32 v74, v74
    v_exp_f32 v75, v75
    s_waitcnt lgkmcnt(3)
    v_smfmac_f32_32x32x32_bf16 v[96:111], v[56:59], v[64:71], v29
    ds_read_b128 v[56:59], v20 offset:6144
    s_add_u32 m0, s45, 33792
    s_add_u32 s46, s45, 230400
    buffer_load_dwordx4 v20, s[20:23], s46 offen sc1 lds
    v_exp_f32 v76, v76
    v_exp_f32 v77, v77
    v_exp_f32 v78, v78
    v_exp_f32 v79, v79
    v_smfmac_f32_16x16x64_bf16 v[112:115], v[24:27], v[64:71], v29
    v_mfma_f32_32x32x16_bf16 v[208:223], v[168:171], v[180:183], 0
    v_exp_f32 v80, v80
    s_waitcnt lgkmcnt(3)
    v_smfmac_f32_32x32x32_bf16 v[96:111], v[60:63], v[72:79], v29
    ds_read_b128 v[60:63], v20 offset:7168
    v_exp_f32 v81, v81
    v_exp_f32 v82, v82
    v_exp_f32 v83, v83
    s_waitcnt lgkmcnt(2)
    v_smfmac_f32_16x16x64_bf16 v[112:115], v[24:27], v[72:79], v29
    v_exp_f32 v84, v84
    v_exp_f32 v85, v85
    v_mfma_f32_32x32x16_bf16 v[64:79], v[116:119], v[32:35], v[40:55]
    s_setprio 1
    v_exp_f32 v86, v86
    v_exp_f32 v87, v87
    v_exp_f32 v88, v88
    v_mfma_f32_32x32x16_bf16 v[64:79], v[120:123], v[36:39], v[64:79]
    ds_read_b128 v[116:119], v20 offset:12288
    ds_read_b128 v[120:123], v20 offset:13312
    v_exp_f32 v89, v89
    v_exp_f32 v90, v90
    v_exp_f32 v91, v91
    s_waitcnt lgkmcnt(3)
    v_smfmac_f32_32x32x32_bf16 v[96:111], v[56:59], v[80:87], v29
    ds_read_b128 v[56:59], v20 offset:10240
    s_add_u32 m0, s45, 34816
    s_add_u32 s46, s45, 231424
    buffer_load_dwordx4 v20, s[20:23], s46 offen sc1 lds
    v_exp_f32 v92, v92
    v_exp_f32 v93, v93
    v_exp_f32 v94, v94
    v_exp_f32 v95, v95
    v_smfmac_f32_16x16x64_bf16 v[112:115], v[24:27], v[80:87], v29
    v_mfma_f32_32x32x16_bf16 v[224:239], v[168:171], v[184:187], 0
    v_exp_f32 v64, v64
    s_waitcnt lgkmcnt(3)
    v_smfmac_f32_32x32x32_bf16 v[96:111], v[60:63], v[88:95], v29
    ds_read_b128 v[60:63], v20 offset:11264
    v_exp_f32 v65, v65
    v_exp_f32 v66, v66
    v_exp_f32 v67, v67
    s_waitcnt lgkmcnt(2)
    v_smfmac_f32_16x16x64_bf16 v[112:115], v[24:27], v[88:95], v29
    v_exp_f32 v68, v68
    v_exp_f32 v69, v69
    v_mfma_f32_32x32x16_bf16 v[80:95], v[116:119], v[32:35], v[40:55]
    s_setprio 0
    v_exp_f32 v70, v70
    v_exp_f32 v71, v71
    v_exp_f32 v72, v72
    v_mfma_f32_32x32x16_bf16 v[80:95], v[120:123], v[36:39], v[80:95]
    ds_read_b128 v[116:119], v20 offset:16384
    ds_read_b128 v[120:123], v20 offset:17408
    v_exp_f32 v73, v73
    v_exp_f32 v74, v74
    v_exp_f32 v75, v75
    s_waitcnt lgkmcnt(3)
    v_smfmac_f32_32x32x32_bf16 v[96:111], v[56:59], v[64:71], v29
    ds_read_b128 v[56:59], v20 offset:14336
    s_add_u32 m0, s45, 35840
    s_add_u32 s46, s45, 232448
    buffer_load_dwordx4 v20, s[20:23], s46 offen sc1 lds
    v_exp_f32 v76, v76
    v_exp_f32 v77, v77
    v_exp_f32 v78, v78
    v_exp_f32 v79, v79
    v_smfmac_f32_16x16x64_bf16 v[112:115], v[24:27], v[64:71], v29
    v_mfma_f32_32x32x16_bf16 v[240:255], v[168:171], v[188:191], 0
    v_exp_f32 v80, v80
    s_waitcnt lgkmcnt(3)
    v_smfmac_f32_32x32x32_bf16 v[96:111], v[60:63], v[72:79], v29
    ds_read_b128 v[60:63], v20 offset:15360
    v_exp_f32 v81, v81
    v_exp_f32 v82, v82
    v_exp_f32 v83, v83
    s_waitcnt lgkmcnt(2)
    v_smfmac_f32_16x16x64_bf16 v[112:115], v[24:27], v[72:79], v29
    v_exp_f32 v84, v84
    v_exp_f32 v85, v85
    v_mfma_f32_32x32x16_bf16 v[64:79], v[116:119], v[32:35], v[40:55]
    s_setprio 3
    v_exp_f32 v86, v86
    v_exp_f32 v87, v87
    v_exp_f32 v88, v88
    v_mfma_f32_32x32x16_bf16 v[64:79], v[120:123], v[36:39], v[64:79]
    ds_read_b128 v[116:119], v20 offset:20480
    ds_read_b128 v[120:123], v20 offset:21504
    v_exp_f32 v89, v89
    v_exp_f32 v90, v90
    v_exp_f32 v91, v91
    s_waitcnt lgkmcnt(3)
    v_smfmac_f32_32x32x32_bf16 v[96:111], v[56:59], v[80:87], v29
    ds_read_b128 v[56:59], v20 offset:18432
    v_exp_f32 v92, v92
    v_exp_f32 v93, v93
    v_exp_f32 v94, v94
    v_exp_f32 v95, v95
    v_smfmac_f32_16x16x64_bf16 v[112:115], v[24:27], v[80:87], v29
    v_mov_b32_dpp v192, v208 quad_perm:[0,1,2,3] row_mask:0xc bank_mask:0xf
    v_mov_b32_dpp v224, v240 quad_perm:[0,1,2,3] row_mask:0xc bank_mask:0xf
    buffer_atomic_add_f32 v192, v165, s[16:19], s95 offen
    buffer_atomic_add_f32 v224, v165, s[16:19], s95 offen offset:256
    v_lshlrev_b32 v16, 11, v3
    v_lshl_add_u32 v16, v4, 5, v16
    s_lshl_b32 s40, s57, 1
    s_add_u32 s40, s40, s49
    s_lshl_b32 s60, s40, 16
    s_lshl_b32 s53, s58, 8
    s_add_u32 s60, s60, s53
    s_lshl_b32 s39, s50, 6
    s_add_u32 s60, s60, s39
    buffer_load_dwordx4 v[8:11], v16, s[4:7], s60 offen
    s_lshl_b32 s38, s58, 1
    s_lshr_b32 s39, s54, 5
    s_cmp_eq_u32 s39, s40
    s_cselect_b32 s44, 1, 0
    v_exp_f32 v64, v64
    s_waitcnt lgkmcnt(3)
    v_smfmac_f32_32x32x32_bf16 v[96:111], v[60:63], v[88:95], v29
    ds_read_b128 v[60:63], v20 offset:19456
    v_exp_f32 v65, v65
    v_exp_f32 v66, v66
    v_exp_f32 v67, v67
    s_waitcnt lgkmcnt(2)
    v_smfmac_f32_16x16x64_bf16 v[112:115], v[24:27], v[88:95], v29
    v_exp_f32 v68, v68
    v_exp_f32 v69, v69
    v_mfma_f32_32x32x16_bf16 v[80:95], v[116:119], v[32:35], v[40:55]
    s_setprio 2
    v_exp_f32 v70, v70
    v_exp_f32 v71, v71
    v_exp_f32 v72, v72
    v_mfma_f32_32x32x16_bf16 v[80:95], v[120:123], v[36:39], v[80:95]
    ds_read_b128 v[116:119], v20 offset:24576
    ds_read_b128 v[120:123], v20 offset:25600
    v_exp_f32 v73, v73
    v_exp_f32 v74, v74
    v_exp_f32 v75, v75
    s_waitcnt lgkmcnt(3)
    v_smfmac_f32_32x32x32_bf16 v[96:111], v[56:59], v[64:71], v29
    ds_read_b128 v[56:59], v20 offset:22528
    v_exp_f32 v76, v76
    v_exp_f32 v77, v77
    v_exp_f32 v78, v78
    v_exp_f32 v79, v79
    v_smfmac_f32_16x16x64_bf16 v[112:115], v[24:27], v[64:71], v29
    s_lshl_b32 s40, s57, 1
    s_add_u32 s40, s40, s49
    s_lshl_b32 s39, s40, 8
    s_add_u32 s39, s39, 0x40000
    v_lshlrev_b32 v5, 3, v3
    buffer_load_dwordx2 v[30:31], v5, s[16:19], s39 offen sc1
    v_exp_f32 v80, v80
    s_waitcnt lgkmcnt(3)
    v_smfmac_f32_32x32x32_bf16 v[96:111], v[60:63], v[72:79], v29
    ds_read_b128 v[60:63], v20 offset:23552
    v_exp_f32 v81, v81
    v_exp_f32 v82, v82
    v_exp_f32 v83, v83
    s_waitcnt lgkmcnt(2)
    v_smfmac_f32_16x16x64_bf16 v[112:115], v[24:27], v[72:79], v29
    v_exp_f32 v84, v84
    v_exp_f32 v85, v85
    v_mfma_f32_32x32x16_bf16 v[64:79], v[116:119], v[32:35], v[40:55]
    s_setprio 1
    v_exp_f32 v86, v86
    v_exp_f32 v87, v87
    v_exp_f32 v88, v88
    v_mfma_f32_32x32x16_bf16 v[64:79], v[120:123], v[36:39], v[64:79]
    ds_read_b128 v[116:119], v20 offset:28672
    ds_read_b128 v[120:123], v20 offset:29696
    v_exp_f32 v89, v89
    v_exp_f32 v90, v90
    v_exp_f32 v91, v91
    s_waitcnt lgkmcnt(3)
    v_smfmac_f32_32x32x32_bf16 v[96:111], v[56:59], v[80:87], v29
    ds_read_b128 v[56:59], v20 offset:26624
    v_exp_f32 v92, v92
    v_exp_f32 v93, v93
    v_exp_f32 v94, v94
    v_exp_f32 v95, v95
    v_smfmac_f32_16x16x64_bf16 v[112:115], v[24:27], v[80:87], v29
    buffer_load_dwordx4 v[12:15], v16, s[4:7], s60 offen offset:16
    s_lshl_b32 s39, s51, 5
    s_lshl_b32 s40, s37, 2
    s_add_u32 s39, s39, s40
    s_add_u32 s39, s39, s50
    s_lshl_b32 s39, s39, 11
    s_add_u32 s59, s39, 0x100000
    v_exp_f32 v64, v64
    s_waitcnt lgkmcnt(3)
    v_smfmac_f32_32x32x32_bf16 v[96:111], v[60:63], v[88:95], v29
    ds_read_b128 v[60:63], v20 offset:27648
    v_exp_f32 v65, v65
    v_exp_f32 v66, v66
    v_exp_f32 v67, v67
    s_waitcnt lgkmcnt(2)
    v_smfmac_f32_16x16x64_bf16 v[112:115], v[24:27], v[88:95], v29
    v_exp_f32 v68, v68
    v_exp_f32 v69, v69
    v_mfma_f32_32x32x16_bf16 v[80:95], v[116:119], v[32:35], v[40:55]
    s_setprio 0
    v_exp_f32 v70, v70
    v_exp_f32 v71, v71
    v_exp_f32 v72, v72
    v_mfma_f32_32x32x16_bf16 v[80:95], v[120:123], v[36:39], v[80:95]
    s_waitcnt vmcnt(5)
    s_barrier
    ds_read_b128 v[116:119], v20 offset:32768
    ds_read_b128 v[120:123], v20 offset:33792
    v_exp_f32 v73, v73
    v_exp_f32 v74, v74
    v_exp_f32 v75, v75
    s_waitcnt lgkmcnt(3)
    v_smfmac_f32_32x32x32_bf16 v[96:111], v[56:59], v[64:71], v29
    ds_read_b128 v[56:59], v20 offset:30720
    v_exp_f32 v76, v76
    v_exp_f32 v77, v77
    v_exp_f32 v78, v78
    v_exp_f32 v79, v79
    v_smfmac_f32_16x16x64_bf16 v[112:115], v[24:27], v[64:71], v29
    s_add_u32 m0, s43, 155648
    s_add_u32 s47, s38, 0
    s_and_b32 s47, s47, 15
    s_lshl_b32 s47, s47, 17
    s_add_u32 s47, s47, s53
    buffer_load_dwordx4 v19, s[8:11], s47 offen lds
    v_exp_f32 v80, v80
    s_waitcnt lgkmcnt(3)
    v_smfmac_f32_32x32x32_bf16 v[96:111], v[60:63], v[72:79], v29
    ds_read_b128 v[60:63], v20 offset:31744
    v_exp_f32 v81, v81
    v_exp_f32 v82, v82
    v_exp_f32 v83, v83
    s_waitcnt lgkmcnt(2)
    v_smfmac_f32_16x16x64_bf16 v[112:115], v[24:27], v[72:79], v29
    v_exp_f32 v84, v84
    v_exp_f32 v85, v85
    v_mfma_f32_32x32x16_bf16 v[64:79], v[116:119], v[32:35], v[40:55]
    s_setprio 3
    v_exp_f32 v86, v86
    v_exp_f32 v87, v87
    v_exp_f32 v88, v88
    v_mfma_f32_32x32x16_bf16 v[64:79], v[120:123], v[36:39], v[64:79]
    ds_read_b128 v[116:119], v20 offset:36864
    ds_read_b128 v[120:123], v20 offset:37888
    v_exp_f32 v89, v89
    v_exp_f32 v90, v90
    v_exp_f32 v91, v91
    s_waitcnt lgkmcnt(3)
    v_smfmac_f32_32x32x32_bf16 v[96:111], v[56:59], v[80:87], v29
    ds_read_b128 v[56:59], v20 offset:34816
    v_exp_f32 v92, v92
    v_exp_f32 v93, v93
    v_exp_f32 v94, v94
    v_exp_f32 v95, v95
    v_smfmac_f32_16x16x64_bf16 v[112:115], v[24:27], v[80:87], v29
    s_add_u32 m0, s43, 147456
    s_add_u32 s47, s38, 0
    s_and_b32 s47, s47, 15
    s_lshl_b32 s47, s47, 17
    s_add_u32 s47, s47, s53
    s_add_u32 s47, s47, 32768
    buffer_load_dwordx4 v19, s[8:11], s47 offen lds
    s_add_u32 m0, s43, 139264
    s_add_u32 s47, s38, 1
    s_and_b32 s47, s47, 15
    s_lshl_b32 s47, s47, 17
    s_add_u32 s47, s47, s53
    buffer_load_dwordx4 v19, s[8:11], s47 offen lds
    v_exp_f32 v64, v64
    s_waitcnt lgkmcnt(3)
    v_smfmac_f32_32x32x32_bf16 v[96:111], v[60:63], v[88:95], v29
    ds_read_b128 v[60:63], v20 offset:35840
    v_exp_f32 v65, v65
    v_exp_f32 v66, v66
    v_exp_f32 v67, v67
    s_waitcnt lgkmcnt(2)
    v_smfmac_f32_16x16x64_bf16 v[112:115], v[24:27], v[88:95], v29
    v_exp_f32 v68, v68
    v_exp_f32 v69, v69
    v_mfma_f32_32x32x16_bf16 v[80:95], v[116:119], v[32:35], v[40:55]
    s_setprio 2
    v_exp_f32 v70, v70
    v_exp_f32 v71, v71
    v_exp_f32 v72, v72
    v_mfma_f32_32x32x16_bf16 v[80:95], v[120:123], v[36:39], v[80:95]
    ds_read_b128 v[116:119], v20 offset:40960
    ds_read_b128 v[120:123], v20 offset:41984
    v_exp_f32 v73, v73
    v_exp_f32 v74, v74
    v_exp_f32 v75, v75
    s_waitcnt lgkmcnt(3)
    v_smfmac_f32_32x32x32_bf16 v[96:111], v[56:59], v[64:71], v29
    ds_read_b128 v[56:59], v20 offset:38912
    v_exp_f32 v76, v76
    v_exp_f32 v77, v77
    v_exp_f32 v78, v78
    v_exp_f32 v79, v79
    v_smfmac_f32_16x16x64_bf16 v[112:115], v[24:27], v[64:71], v29
    s_add_u32 m0, s43, 131072
    s_add_u32 s47, s38, 1
    s_and_b32 s47, s47, 15
    s_lshl_b32 s47, s47, 17
    s_add_u32 s47, s47, s53
    s_add_u32 s47, s47, 32768
    buffer_load_dwordx4 v19, s[8:11], s47 offen lds
    v_exp_f32 v80, v80
    s_waitcnt lgkmcnt(3)
    v_smfmac_f32_32x32x32_bf16 v[96:111], v[60:63], v[72:79], v29
    ds_read_b128 v[60:63], v20 offset:39936
    v_exp_f32 v81, v81
    v_exp_f32 v82, v82
    v_exp_f32 v83, v83
    s_waitcnt lgkmcnt(2)
    v_smfmac_f32_16x16x64_bf16 v[112:115], v[24:27], v[72:79], v29
    v_exp_f32 v84, v84
    v_exp_f32 v85, v85
    v_mfma_f32_32x32x16_bf16 v[64:79], v[116:119], v[32:35], v[40:55]
    s_setprio 1
    v_exp_f32 v86, v86
    v_exp_f32 v87, v87
    v_exp_f32 v88, v88
    v_mfma_f32_32x32x16_bf16 v[64:79], v[120:123], v[36:39], v[64:79]
    ds_read_b128 v[116:119], v20 offset:45056
    ds_read_b128 v[120:123], v20 offset:46080
    v_exp_f32 v89, v89
    v_exp_f32 v90, v90
    v_exp_f32 v91, v91
    s_waitcnt lgkmcnt(3)
    v_smfmac_f32_32x32x32_bf16 v[96:111], v[56:59], v[80:87], v29
    ds_read_b128 v[56:59], v20 offset:43008
    v_exp_f32 v92, v92
    v_exp_f32 v93, v93
    v_exp_f32 v94, v94
    v_exp_f32 v95, v95
    v_smfmac_f32_16x16x64_bf16 v[112:115], v[24:27], v[80:87], v29
    s_add_u32 m0, s43, 122880
    s_add_u32 s47, s38, 2
    s_and_b32 s47, s47, 15
    s_lshl_b32 s47, s47, 17
    s_add_u32 s47, s47, s53
    buffer_load_dwordx4 v19, s[8:11], s47 offen lds
    s_add_u32 m0, s43, 114688
    s_add_u32 s47, s38, 2
    s_and_b32 s47, s47, 15
    s_lshl_b32 s47, s47, 17
    s_add_u32 s47, s47, s53
    s_add_u32 s47, s47, 32768
    buffer_load_dwordx4 v19, s[8:11], s47 offen lds
    v_exp_f32 v64, v64
    s_waitcnt lgkmcnt(3)
    v_smfmac_f32_32x32x32_bf16 v[96:111], v[60:63], v[88:95], v29
    ds_read_b128 v[60:63], v20 offset:44032
    v_exp_f32 v65, v65
    v_exp_f32 v66, v66
    v_exp_f32 v67, v67
    s_waitcnt lgkmcnt(2)
    v_smfmac_f32_16x16x64_bf16 v[112:115], v[24:27], v[88:95], v29
    v_exp_f32 v68, v68
    v_exp_f32 v69, v69
    v_mfma_f32_32x32x16_bf16 v[80:95], v[116:119], v[32:35], v[40:55]
    s_setprio 0
    v_exp_f32 v70, v70
    v_exp_f32 v71, v71
    v_exp_f32 v72, v72
    v_mfma_f32_32x32x16_bf16 v[80:95], v[120:123], v[36:39], v[80:95]
    ds_read_b128 v[116:119], v20 offset:49152
    ds_read_b128 v[120:123], v20 offset:50176
    v_exp_f32 v73, v73
    v_exp_f32 v74, v74
    v_exp_f32 v75, v75
    s_waitcnt lgkmcnt(3)
    v_smfmac_f32_32x32x32_bf16 v[96:111], v[56:59], v[64:71], v29
    ds_read_b128 v[56:59], v20 offset:47104
    v_exp_f32 v76, v76
    v_exp_f32 v77, v77
    v_exp_f32 v78, v78
    v_exp_f32 v79, v79
    v_smfmac_f32_16x16x64_bf16 v[112:115], v[24:27], v[64:71], v29
    s_add_u32 m0, s43, 106496
    s_add_u32 s47, s38, 3
    s_and_b32 s47, s47, 15
    s_lshl_b32 s47, s47, 17
    s_add_u32 s47, s47, s53
    buffer_load_dwordx4 v19, s[8:11], s47 offen lds
    v_exp_f32 v80, v80
    s_waitcnt lgkmcnt(3)
    v_smfmac_f32_32x32x32_bf16 v[96:111], v[60:63], v[72:79], v29
    ds_read_b128 v[60:63], v20 offset:48128
    v_exp_f32 v81, v81
    v_exp_f32 v82, v82
    v_exp_f32 v83, v83
    s_waitcnt lgkmcnt(2)
    v_smfmac_f32_16x16x64_bf16 v[112:115], v[24:27], v[72:79], v29
    v_exp_f32 v84, v84
    v_exp_f32 v85, v85
    v_mfma_f32_32x32x16_bf16 v[64:79], v[116:119], v[32:35], v[40:55]
    s_setprio 3
    v_exp_f32 v86, v86
    v_exp_f32 v87, v87
    v_exp_f32 v88, v88
    v_mfma_f32_32x32x16_bf16 v[64:79], v[120:123], v[36:39], v[64:79]
    ds_read_b128 v[116:119], v20 offset:53248
    ds_read_b128 v[120:123], v20 offset:54272
    v_exp_f32 v89, v89
    v_exp_f32 v90, v90
    v_exp_f32 v91, v91
    s_waitcnt lgkmcnt(3)
    v_smfmac_f32_32x32x32_bf16 v[96:111], v[56:59], v[80:87], v29
    ds_read_b128 v[56:59], v20 offset:51200
    v_exp_f32 v92, v92
    v_exp_f32 v93, v93
    v_exp_f32 v94, v94
    v_exp_f32 v95, v95
    v_smfmac_f32_16x16x64_bf16 v[112:115], v[24:27], v[80:87], v29
    s_waitcnt vmcnt(10)
    s_lshr_b32 s39, s2, 3
    s_lshl_b32 s39, s39, 7
    s_add_u32 s39, s39, 0x68000
    v_mov_b32 v174, 1
    s_mov_b64 exec, 1
    buffer_atomic_add v174, v165, s[16:19], s39 offen sc1
    s_mov_b64 exec, -1
    s_add_u32 m0, s43, 98304
    s_add_u32 s47, s38, 3
    s_and_b32 s47, s47, 15
    s_lshl_b32 s47, s47, 17
    s_add_u32 s47, s47, s53
    s_add_u32 s47, s47, 32768
    buffer_load_dwordx4 v19, s[8:11], s47 offen lds
    s_add_u32 m0, s43, 90112
    s_add_u32 s47, s38, 4
    s_and_b32 s47, s47, 15
    s_lshl_b32 s47, s47, 17
    s_add_u32 s47, s47, s53
    buffer_load_dwordx4 v19, s[8:11], s47 offen lds
    v_exp_f32 v64, v64
    s_waitcnt lgkmcnt(3)
    v_smfmac_f32_32x32x32_bf16 v[96:111], v[60:63], v[88:95], v29
    ds_read_b128 v[60:63], v20 offset:52224
    v_exp_f32 v65, v65
    v_exp_f32 v66, v66
    v_exp_f32 v67, v67
    s_waitcnt lgkmcnt(2)
    v_smfmac_f32_16x16x64_bf16 v[112:115], v[24:27], v[88:95], v29
    v_exp_f32 v68, v68
    v_exp_f32 v69, v69
    v_mfma_f32_32x32x16_bf16 v[80:95], v[116:119], v[32:35], v[40:55]
    s_setprio 2
    v_exp_f32 v70, v70
    v_exp_f32 v71, v71
    v_exp_f32 v72, v72
    v_mfma_f32_32x32x16_bf16 v[80:95], v[120:123], v[36:39], v[80:95]
    ds_read_b128 v[116:119], v20 offset:57344
    ds_read_b128 v[120:123], v20 offset:58368
    v_exp_f32 v73, v73
    v_exp_f32 v74, v74
    v_exp_f32 v75, v75
    s_waitcnt lgkmcnt(3)
    v_smfmac_f32_32x32x32_bf16 v[96:111], v[56:59], v[64:71], v29
    ds_read_b128 v[56:59], v20 offset:55296
    v_exp_f32 v76, v76
    v_exp_f32 v77, v77
    v_exp_f32 v78, v78
    v_exp_f32 v79, v79
    v_smfmac_f32_16x16x64_bf16 v[112:115], v[24:27], v[64:71], v29
    s_add_u32 m0, s43, 81920
    s_add_u32 s47, s38, 4
    s_and_b32 s47, s47, 15
    s_lshl_b32 s47, s47, 17
    s_add_u32 s47, s47, s53
    s_add_u32 s47, s47, 32768
    buffer_load_dwordx4 v19, s[8:11], s47 offen lds
    v_exp_f32 v80, v80
    s_waitcnt lgkmcnt(3)
    v_smfmac_f32_32x32x32_bf16 v[96:111], v[60:63], v[72:79], v29
    ds_read_b128 v[60:63], v20 offset:56320
    v_exp_f32 v81, v81
    v_exp_f32 v82, v82
    v_exp_f32 v83, v83
    s_waitcnt lgkmcnt(2)
    v_smfmac_f32_16x16x64_bf16 v[112:115], v[24:27], v[72:79], v29
    v_exp_f32 v84, v84
    v_exp_f32 v85, v85
    v_mfma_f32_32x32x16_bf16 v[64:79], v[116:119], v[32:35], v[40:55]
    s_setprio 1
    v_exp_f32 v86, v86
    v_exp_f32 v87, v87
    v_exp_f32 v88, v88
    v_mfma_f32_32x32x16_bf16 v[64:79], v[120:123], v[36:39], v[64:79]
    ds_read_b128 v[116:119], v20 offset:61440
    ds_read_b128 v[120:123], v20 offset:62464
    v_exp_f32 v89, v89
    v_exp_f32 v90, v90
    v_exp_f32 v91, v91
    s_waitcnt lgkmcnt(3)
    v_smfmac_f32_32x32x32_bf16 v[96:111], v[56:59], v[80:87], v29
    ds_read_b128 v[56:59], v20 offset:59392
    v_exp_f32 v92, v92
    v_exp_f32 v93, v93
    v_exp_f32 v94, v94
    v_exp_f32 v95, v95
    v_smfmac_f32_16x16x64_bf16 v[112:115], v[24:27], v[80:87], v29
    s_add_u32 m0, s43, 73728
    s_add_u32 s47, s38, 5
    s_and_b32 s47, s47, 15
    s_lshl_b32 s47, s47, 17
    s_add_u32 s47, s47, s53
    buffer_load_dwordx4 v19, s[8:11], s47 offen lds
    s_add_u32 m0, s43, 65536
    s_add_u32 s47, s38, 5
    s_and_b32 s47, s47, 15
    s_lshl_b32 s47, s47, 17
    s_add_u32 s47, s47, s53
    s_add_u32 s47, s47, 32768
    buffer_load_dwordx4 v19, s[8:11], s47 offen lds
    v_exp_f32 v64, v64
    s_waitcnt lgkmcnt(3)
    v_smfmac_f32_32x32x32_bf16 v[96:111], v[60:63], v[88:95], v29
    ds_read_b128 v[60:63], v20 offset:60416
    v_exp_f32 v65, v65
    v_exp_f32 v66, v66
    v_exp_f32 v67, v67
    s_waitcnt lgkmcnt(2)
    v_smfmac_f32_16x16x64_bf16 v[112:115], v[24:27], v[88:95], v29
    v_exp_f32 v68, v68
    v_exp_f32 v69, v69
    v_mfma_f32_32x32x16_bf16 v[80:95], v[116:119], v[32:35], v[40:55]
    s_setprio 0
    v_exp_f32 v70, v70
    v_exp_f32 v71, v71
    v_exp_f32 v72, v72
    v_mfma_f32_32x32x16_bf16 v[80:95], v[120:123], v[36:39], v[80:95]
    v_exp_f32 v73, v73
    v_exp_f32 v74, v74
    v_exp_f32 v75, v75
    s_waitcnt lgkmcnt(1)
    v_smfmac_f32_32x32x32_bf16 v[96:111], v[56:59], v[64:71], v29
    ds_read_b128 v[56:59], v20 offset:63488
    v_exp_f32 v76, v76
    v_exp_f32 v77, v77
    v_exp_f32 v78, v78
    v_exp_f32 v79, v79
    v_smfmac_f32_16x16x64_bf16 v[112:115], v[24:27], v[64:71], v29
    s_nop 0
    v_exp_f32 v80, v80
    s_waitcnt lgkmcnt(1)
    v_smfmac_f32_32x32x32_bf16 v[96:111], v[60:63], v[72:79], v29
    ds_read_b128 v[60:63], v20 offset:64512
    v_exp_f32 v81, v81
    v_exp_f32 v82, v82
    v_exp_f32 v83, v83
    v_smfmac_f32_16x16x64_bf16 v[112:115], v[24:27], v[72:79], v29
    v_exp_f32 v84, v84
    v_exp_f32 v85, v85
    s_setprio 3
    v_exp_f32 v86, v86
    v_exp_f32 v87, v87
    v_exp_f32 v88, v88
    v_exp_f32 v89, v89
    v_exp_f32 v90, v90
    v_exp_f32 v91, v91
    s_waitcnt lgkmcnt(1)
    v_smfmac_f32_32x32x32_bf16 v[96:111], v[56:59], v[80:87], v29
    v_exp_f32 v92, v92
    v_exp_f32 v93, v93
    v_exp_f32 v94, v94
    v_exp_f32 v95, v95
    v_smfmac_f32_16x16x64_bf16 v[112:115], v[24:27], v[80:87], v29
    s_setprio 0
    s_waitcnt lgkmcnt(0)
    v_smfmac_f32_32x32x32_bf16 v[96:111], v[60:63], v[88:95], v29
    v_smfmac_f32_16x16x64_bf16 v[112:115], v[24:27], v[88:95], v29
    v_bfe_u32 v5, v2, 2, 2
    v_lshl_add_u32 v6, v4, 2, v5
    v_lshlrev_b32 v6, 6, v6
    v_and_b32 v5, 1, v2
    v_lshl_add_u32 v6, v5, 5, v6
    v_bfe_u32 v5, v2, 4, 1
    v_lshl_add_u32 v6, v5, 4, v6
    v_bfe_u32 v5, v2, 1, 1
    v_lshl_add_u32 v6, v5, 3, v6
    v_add_u32 v17, s43, v6
    v_add_u32 v18, 0x10000, v17
    v_add_u32 v1, 0x20000, v17
    v_mov_b32 v6, 0x5f800000
    v_pk_add_f32 v[64:65], v[96:97], v[98:99]
    v_pk_add_f32 v[66:67], v[100:101], v[102:103]
    v_pk_add_f32 v[68:69], v[104:105], v[106:107]
    v_pk_add_f32 v[70:71], v[108:109], v[110:111]
    v_pk_add_f32 v[64:65], v[64:65], v[66:67]
    v_pk_add_f32 v[68:69], v[68:69], v[70:71]
    v_pk_add_f32 v[64:65], v[64:65], v[68:69]
    v_add_f32 v5, v64, v65
    v_fma_f32 v5, v5, 0, v112
    v_cmp_nlt_f32 vcc, v5, v6
    s_nop 1
    s_cbranch_vccnz L_fallback
L_fin:
    v_rcp_f32 v6, v112
    s_nop 0
    v_pk_mul_f32 v[96:97], v[96:97], v[6:7] op_sel_hi:[1,0]
    v_pk_mul_f32 v[98:99], v[98:99], v[6:7] op_sel_hi:[1,0]
    v_pk_mul_f32 v[100:101], v[100:101], v[6:7] op_sel_hi:[1,0]
    v_pk_mul_f32 v[102:103], v[102:103], v[6:7] op_sel_hi:[1,0]
    v_pk_mul_f32 v[104:105], v[104:105], v[6:7] op_sel_hi:[1,0]
    v_pk_mul_f32 v[106:107], v[106:107], v[6:7] op_sel_hi:[1,0]
    v_pk_mul_f32 v[108:109], v[108:109], v[6:7] op_sel_hi:[1,0]
    v_pk_mul_f32 v[110:111], v[110:111], v[6:7] op_sel_hi:[1,0]
    v_cvt_pk_bf16_f32 v64, v96, v97
    v_cvt_pk_bf16_f32 v65, v98, v99
    v_cvt_pk_bf16_f32 v66, v100, v101
    v_cvt_pk_bf16_f32 v67, v102, v103
    v_cvt_pk_bf16_f32 v68, v104, v105
    v_cvt_pk_bf16_f32 v69, v106, v107
    v_cvt_pk_bf16_f32 v70, v108, v109
    v_cvt_pk_bf16_f32 v71, v110, v111
    buffer_store_dwordx4 v[64:67], v20, s[16:19], s59 offen sc1
    buffer_store_dwordx4 v[68:71], v20, s[16:19], s59 offen offset:1024 sc1
    s_waitcnt vmcnt(14)
    ds_read_b64_tr_b16 v[128:129], v1 offset:24576
    ds_read_b64_tr_b16 v[130:131], v1 offset:25088
    s_waitcnt vmcnt(13)
    ds_read_b64_tr_b16 v[132:133], v1 offset:16384
    ds_read_b64_tr_b16 v[134:135], v1 offset:16896
    s_waitcnt vmcnt(12)
    ds_read_b64_tr_b16 v[136:137], v1 offset:8192
    ds_read_b64_tr_b16 v[138:139], v1 offset:8704
    s_waitcnt vmcnt(11)
    ds_read_b64_tr_b16 v[140:141], v1 offset:0
    ds_read_b64_tr_b16 v[142:143], v1 offset:512
    s_waitcnt vmcnt(10)
    ds_read_b64_tr_b16 v[144:145], v18 offset:57344
    ds_read_b64_tr_b16 v[146:147], v18 offset:57856
    s_waitcnt vmcnt(9)
    ds_read_b64_tr_b16 v[148:149], v18 offset:49152
    ds_read_b64_tr_b16 v[150:151], v18 offset:49664
    s_waitcnt vmcnt(8)
    ds_read_b64_tr_b16 v[152:153], v18 offset:40960
    ds_read_b64_tr_b16 v[154:155], v18 offset:41472
    s_waitcnt vmcnt(6)
    ds_read_b64_tr_b16 v[156:157], v18 offset:32768
    ds_read_b64_tr_b16 v[158:159], v18 offset:33280
    s_waitcnt vmcnt(5)
    ds_read_b64_tr_b16 v[160:161], v18 offset:24576
    ds_read_b64_tr_b16 v[162:163], v18 offset:25088
    s_waitcnt vmcnt(4)
    ds_read_b64_tr_b16 v[164:165], v18 offset:16384
    ds_read_b64_tr_b16 v[166:167], v18 offset:16896
    s_waitcnt vmcnt(3)
    ds_read_b64_tr_b16 v[168:169], v18 offset:8192
    ds_read_b64_tr_b16 v[170:171], v18 offset:8704
    s_waitcnt vmcnt(2)
    ds_read_b64_tr_b16 v[172:173], v18 offset:0
    ds_read_b64_tr_b16 v[174:175], v18 offset:512
    s_waitcnt lgkmcnt(15)
    s_add_u32 m0, s43, 155648
    s_add_u32 s47, s38, 6
    s_and_b32 s47, s47, 15
    s_lshl_b32 s47, s47, 17
    s_add_u32 s47, s47, s53
    buffer_load_dwordx4 v19, s[8:11], s47 offen lds
    s_add_u32 m0, s43, 147456
    s_add_u32 s47, s38, 6
    s_and_b32 s47, s47, 15
    s_lshl_b32 s47, s47, 17
    s_add_u32 s47, s47, s53
    s_add_u32 s47, s47, 32768
    buffer_load_dwordx4 v19, s[8:11], s47 offen lds
    s_add_u32 m0, s43, 139264
    s_add_u32 s47, s38, 7
    s_and_b32 s47, s47, 15
    s_lshl_b32 s47, s47, 17
    s_add_u32 s47, s47, s53
    buffer_load_dwordx4 v19, s[8:11], s47 offen lds
    s_add_u32 m0, s43, 131072
    s_add_u32 s47, s38, 7
    s_and_b32 s47, s47, 15
    s_lshl_b32 s47, s47, 17
    s_add_u32 s47, s47, s53
    s_add_u32 s47, s47, 32768
    buffer_load_dwordx4 v19, s[8:11], s47 offen lds
    s_lshl_b32 s39, s36, 3
    s_add_u32 s39, s39, s37
    s_lshl_b32 s39, s39, 7
    s_add_u32 s39, s39, 0x70000
    v_mov_b32 v5, 1
    v_mov_b32 v6, 0
    s_waitcnt vmcnt(4)
    s_barrier
    s_cmp_eq_u32 s3, 0
    s_cbranch_scc0 L_57
    s_mov_b64 exec, 1
    buffer_atomic_add v5, v6, s[16:19], s39 offen sc1
    s_mov_b64 exec, -1
L_57:
    s_waitcnt lgkmcnt(14)
    s_waitcnt lgkmcnt(12)
    s_waitcnt lgkmcnt(10)
    s_waitcnt lgkmcnt(8)
    s_waitcnt lgkmcnt(6)
    s_waitcnt lgkmcnt(4)
    s_waitcnt lgkmcnt(2)
    s_waitcnt lgkmcnt(0)
    v_and_b32 v64, 7, v2
    v_lshlrev_b32 v64, 7, v64
    s_lshl_b32 s42, s57, 10
    s_add_u32 s42, s42, 0x70000
    s_add_u32 m0, s43, 122880
    s_add_u32 s47, s38, 8
    s_and_b32 s47, s47, 15
    s_lshl_b32 s47, s47, 17
    s_add_u32 s47, s47, s53
    buffer_load_dwordx4 v19, s[8:11], s47 offen lds
    v_lshlrev_b32 v32, 16, v8
    v_and_b32 v33, 0xffff0000, v8
    v_sub_f32 v48, v32, v30
    v_sub_f32 v49, v33, v30
    v_cvt_pk_bf16_f32 v6, v48, v49
    v_lshlrev_b32 v48, 16, v6
    v_and_b32 v49, 0xffff0000, v6
    v_mul_f32 v48, v48, v31
    s_add_u32 m0, s43, 114688
    s_add_u32 s47, s38, 8
    s_and_b32 s47, s47, 15
    s_lshl_b32 s47, s47, 17
    s_add_u32 s47, s47, s53
    s_add_u32 s47, s47, 32768
    buffer_load_dwordx4 v19, s[8:11], s47 offen lds
    v_mul_f32 v49, v49, v31
    v_cvt_pk_bf16_f32 v6, v48, v49
    v_lshlrev_b32 v48, 16, v6
    v_and_b32 v49, 0xffff0000, v6
    v_lshlrev_b32 v34, 16, v9
    v_and_b32 v35, 0xffff0000, v9
    v_sub_f32 v50, v34, v30
    v_sub_f32 v51, v35, v30
    s_add_u32 m0, s43, 106496
    s_add_u32 s47, s38, 9
    s_and_b32 s47, s47, 15
    s_lshl_b32 s47, s47, 17
    s_add_u32 s47, s47, s53
    buffer_load_dwordx4 v19, s[8:11], s47 offen lds
    v_cvt_pk_bf16_f32 v6, v50, v51
    v_lshlrev_b32 v50, 16, v6
    v_and_b32 v51, 0xffff0000, v6
    v_mul_f32 v50, v50, v31
    v_mul_f32 v51, v51, v31
    v_cvt_pk_bf16_f32 v6, v50, v51
    v_lshlrev_b32 v50, 16, v6
    v_and_b32 v51, 0xffff0000, v6
    s_waitcnt vmcnt(6)
    ds_read_b64_tr_b16 v[176:177], v1 offset:24576
    ds_read_b64_tr_b16 v[178:179], v1 offset:25088
    s_add_u32 m0, s43, 98304
    s_add_u32 s47, s38, 9
    s_and_b32 s47, s47, 15
    s_lshl_b32 s47, s47, 17
    s_add_u32 s47, s47, s53
    s_add_u32 s47, s47, 32768
    buffer_load_dwordx4 v19, s[8:11], s47 offen lds
    v_lshlrev_b32 v36, 16, v10
    v_and_b32 v37, 0xffff0000, v10
    v_sub_f32 v52, v36, v30
    v_sub_f32 v53, v37, v30
    v_cvt_pk_bf16_f32 v6, v52, v53
    v_lshlrev_b32 v52, 16, v6
    v_and_b32 v53, 0xffff0000, v6
    v_mul_f32 v52, v52, v31
    s_waitcnt vmcnt(6)
    ds_read_b64_tr_b16 v[180:181], v1 offset:16384
    ds_read_b64_tr_b16 v[182:183], v1 offset:16896
    s_add_u32 m0, s43, 90112
    s_add_u32 s47, s38, 10
    s_and_b32 s47, s47, 15
    s_lshl_b32 s47, s47, 17
    s_add_u32 s47, s47, s53
    buffer_load_dwordx4 v19, s[8:11], s47 offen lds
    v_mul_f32 v53, v53, v31
    v_cvt_pk_bf16_f32 v6, v52, v53
    v_lshlrev_b32 v52, 16, v6
    v_and_b32 v53, 0xffff0000, v6
    v_lshlrev_b32 v38, 16, v11
    v_and_b32 v39, 0xffff0000, v11
    v_sub_f32 v54, v38, v30
    v_sub_f32 v55, v39, v30
    s_waitcnt vmcnt(6)
    ds_read_b64_tr_b16 v[184:185], v1 offset:8192
    ds_read_b64_tr_b16 v[186:187], v1 offset:8704
    s_add_u32 m0, s43, 81920
    s_add_u32 s47, s38, 10
    s_and_b32 s47, s47, 15
    s_lshl_b32 s47, s47, 17
    s_add_u32 s47, s47, s53
    s_add_u32 s47, s47, 32768
    buffer_load_dwordx4 v19, s[8:11], s47 offen lds
    v_cvt_pk_bf16_f32 v6, v54, v55
    v_lshlrev_b32 v54, 16, v6
    v_and_b32 v55, 0xffff0000, v6
    v_mul_f32 v54, v54, v31
    v_mul_f32 v55, v55, v31
    v_cvt_pk_bf16_f32 v6, v54, v55
    v_lshlrev_b32 v54, 16, v6
    v_and_b32 v55, 0xffff0000, v6
    s_waitcnt vmcnt(6)
    ds_read_b64_tr_b16 v[188:189], v1 offset:0
    ds_read_b64_tr_b16 v[190:191], v1 offset:512
    s_add_u32 m0, s43, 73728
    s_add_u32 s47, s38, 11
    s_and_b32 s47, s47, 15
    s_lshl_b32 s47, s47, 17
    s_add_u32 s47, s47, s53
    buffer_load_dwordx4 v19, s[8:11], s47 offen lds
    v_lshlrev_b32 v40, 16, v12
    v_and_b32 v41, 0xffff0000, v12
    v_sub_f32 v56, v40, v30
    v_sub_f32 v57, v41, v30
    v_cvt_pk_bf16_f32 v6, v56, v57
    v_lshlrev_b32 v56, 16, v6
    v_and_b32 v57, 0xffff0000, v6
    v_mul_f32 v56, v56, v31
    s_waitcnt vmcnt(6)
    ds_read_b64_tr_b16 v[192:193], v18 offset:57344
    ds_read_b64_tr_b16 v[194:195], v18 offset:57856
    s_add_u32 m0, s43, 65536
    s_add_u32 s47, s38, 11
    s_and_b32 s47, s47, 15
    s_lshl_b32 s47, s47, 17
    s_add_u32 s47, s47, s53
    s_add_u32 s47, s47, 32768
    buffer_load_dwordx4 v19, s[8:11], s47 offen lds
    v_mul_f32 v57, v57, v31
    v_cvt_pk_bf16_f32 v6, v56, v57
    v_lshlrev_b32 v56, 16, v6
    v_and_b32 v57, 0xffff0000, v6
    v_lshlrev_b32 v42, 16, v13
    v_and_b32 v43, 0xffff0000, v13
    v_sub_f32 v58, v42, v30
    v_sub_f32 v59, v43, v30
    s_waitcnt vmcnt(6)
    ds_read_b64_tr_b16 v[196:197], v18 offset:49152
    ds_read_b64_tr_b16 v[198:199], v18 offset:49664
    s_cmp_eq_u32 s3, 7
    s_cbranch_scc0 L_58
    buffer_load_dword v65, v64, s[16:19], s42 offen sc1
L_58:
    s_lshl_b32 s62, s57, 1
    s_lshr_b32 s39, s3, 2
    s_add_u32 s62, s62, s39
    s_lshl_b32 s62, s62, 16
    s_and_b32 s39, s3, 3
    s_lshl_b32 s39, s39, 10
    s_add_u32 s62, s62, s39
    s_add_u32 s62, s62, 0x100000
    s_mul_i32 s39, s49, 6144
    v_add_u32 v24, s39, v20
    v_xor_b32 v25, 0x1000, v24
    v_add_u32 v26, 0x10000, v24
    v_add_u32 v27, 0x10000, v25
    s_waitcnt vmcnt(5)
    ds_read_b64_tr_b16 v[200:201], v18 offset:40960
    ds_read_b64_tr_b16 v[202:203], v18 offset:41472
    v_cvt_pk_bf16_f32 v6, v58, v59
    v_lshlrev_b32 v58, 16, v6
    v_and_b32 v59, 0xffff0000, v6
    v_mul_f32 v58, v58, v31
    v_mul_f32 v59, v59, v31
    v_cvt_pk_bf16_f32 v6, v58, v59
    s_waitcnt vmcnt(4)
    ds_read_b64_tr_b16 v[204:205], v18 offset:32768
    ds_read_b64_tr_b16 v[206:207], v18 offset:33280
    v_lshlrev_b32 v58, 16, v6
    v_and_b32 v59, 0xffff0000, v6
    v_lshlrev_b32 v44, 16, v14
    v_and_b32 v45, 0xffff0000, v14
    v_sub_f32 v60, v44, v30
    v_sub_f32 v61, v45, v30
    s_waitcnt vmcnt(3)
    ds_read_b64_tr_b16 v[208:209], v18 offset:24576
    ds_read_b64_tr_b16 v[210:211], v18 offset:25088
    v_cvt_pk_bf16_f32 v6, v60, v61
    v_lshlrev_b32 v60, 16, v6
    v_and_b32 v61, 0xffff0000, v6
    v_mul_f32 v60, v60, v31
    v_mul_f32 v61, v61, v31
    v_cvt_pk_bf16_f32 v6, v60, v61
    s_waitcnt vmcnt(2)
    ds_read_b64_tr_b16 v[212:213], v18 offset:16384
    ds_read_b64_tr_b16 v[214:215], v18 offset:16896
    v_lshlrev_b32 v60, 16, v6
    v_and_b32 v61, 0xffff0000, v6
    v_lshlrev_b32 v46, 16, v15
    v_and_b32 v47, 0xffff0000, v15
    v_sub_f32 v62, v46, v30
    v_sub_f32 v63, v47, v30
    s_waitcnt vmcnt(1)
    ds_read_b64_tr_b16 v[216:217], v18 offset:8192
    ds_read_b64_tr_b16 v[218:219], v18 offset:8704
    v_cvt_pk_bf16_f32 v6, v62, v63
    v_lshlrev_b32 v62, 16, v6
    v_and_b32 v63, 0xffff0000, v6
    v_mul_f32 v62, v62, v31
    v_mul_f32 v63, v63, v31
    v_cvt_pk_bf16_f32 v6, v62, v63
    s_waitcnt vmcnt(0)
    ds_read_b64_tr_b16 v[220:221], v18 offset:0
    ds_read_b64_tr_b16 v[222:223], v18 offset:512
    v_lshlrev_b32 v62, 16, v6
    v_and_b32 v63, 0xffff0000, v6
    v_mul_f32 v6, 0xbfb8aa3b, v48
    v_mul_f32 v7, 0xbfb8aa3b, v49
    v_exp_f32 v6, v6
    v_exp_f32 v7, v7
    s_waitcnt lgkmcnt(0)
    s_cmp_eq_u32 s3, 7
    s_cbranch_scc0 L_59
    s_mov_b32 s41, 0
    s_branch pchk_61
poll_60:
    buffer_load_dword v65, v64, s[16:19], s42 offen sc1
    s_waitcnt vmcnt(0)
pchk_61:
    v_cmp_ne_u32 vcc, 1, v65
    s_add_u32 s41, s41, 1
    s_cbranch_vccz pdone_62
    s_sleep 2
    s_cmp_lt_u32 s41, 200000
    s_cbranch_scc1 poll_60
pdone_62:
L_59:
    s_barrier
    s_add_u32 m0, s43, 0
    s_add_u32 s47, s38, 0
    s_and_b32 s47, s47, 15
    s_lshl_b32 s47, s47, 12
    s_add_u32 s47, s47, s62
    buffer_load_dwordx4 v20, s[16:19], s47 offen sc1 lds
    v_add_f32 v6, 1.0, v6
    v_add_f32 v7, 1.0, v7
    v_rcp_f32 v6, v6
    v_rcp_f32 v7, v7
    v_mul_f32 v48, v48, v6
    v_mul_f32 v49, v49, v7
    v_cvt_pk_bf16_f32 v6, v48, v49
    v_lshlrev_b32 v48, 16, v6
    s_add_u32 m0, s43, 8192
    s_add_u32 s47, s38, 1
    s_and_b32 s47, s47, 15
    s_lshl_b32 s47, s47, 12
    s_add_u32 s47, s47, s62
    buffer_load_dwordx4 v20, s[16:19], s47 offen sc1 lds
    v_and_b32 v49, 0xffff0000, v6
    v_mul_f32 v6, 0xbfb8aa3b, v50
    v_mul_f32 v7, 0xbfb8aa3b, v51
    v_exp_f32 v6, v6
    v_exp_f32 v7, v7
    v_add_f32 v6, 1.0, v6
    v_add_f32 v7, 1.0, v7
    v_rcp_f32 v6, v6
    s_add_u32 m0, s43, 16384
    s_add_u32 s47, s38, 2
    s_and_b32 s47, s47, 15
    s_lshl_b32 s47, s47, 12
    s_add_u32 s47, s47, s62
    buffer_load_dwordx4 v20, s[16:19], s47 offen sc1 lds
    v_rcp_f32 v7, v7
    v_mul_f32 v50, v50, v6
    v_mul_f32 v51, v51, v7
    v_cvt_pk_bf16_f32 v6, v50, v51
    v_lshlrev_b32 v50, 16, v6
    v_and_b32 v51, 0xffff0000, v6
    v_mul_f32 v6, 0xbfb8aa3b, v52
    v_mul_f32 v7, 0xbfb8aa3b, v53
    s_add_u32 m0, s43, 24576
    s_add_u32 s47, s38, 3
    s_and_b32 s47, s47, 15
    s_lshl_b32 s47, s47, 12
    s_add_u32 s47, s47, s62
    buffer_load_dwordx4 v20, s[16:19], s47 offen sc1 lds
    v_exp_f32 v6, v6
    v_exp_f32 v7, v7
    v_add_f32 v6, 1.0, v6
    v_add_f32 v7, 1.0, v7
    v_rcp_f32 v6, v6
    v_rcp_f32 v7, v7
    v_mul_f32 v52, v52, v6
    v_mul_f32 v53, v53, v7
    s_add_u32 m0, s43, 32768
    s_add_u32 s47, s38, 4
    s_and_b32 s47, s47, 15
    s_lshl_b32 s47, s47, 12
    s_add_u32 s47, s47, s62
    buffer_load_dwordx4 v20, s[16:19], s47 offen sc1 lds
    v_cvt_pk_bf16_f32 v6, v52, v53
    v_lshlrev_b32 v52, 16, v6
    v_and_b32 v53, 0xffff0000, v6
    v_mul_f32 v6, 0xbfb8aa3b, v54
    v_mul_f32 v7, 0xbfb8aa3b, v55
    v_exp_f32 v6, v6
    v_exp_f32 v7, v7
    v_add_f32 v6, 1.0, v6
    s_add_u32 m0, s43, 40960
    s_add_u32 s47, s38, 5
    s_and_b32 s47, s47, 15
    s_lshl_b32 s47, s47, 12
    s_add_u32 s47, s47, s62
    buffer_load_dwordx4 v20, s[16:19], s47 offen sc1 lds
    v_add_f32 v7, 1.0, v7
    v_rcp_f32 v6, v6
    v_rcp_f32 v7, v7
    v_mul_f32 v54, v54, v6
    v_mul_f32 v55, v55, v7
    v_cvt_pk_bf16_f32 v6, v54, v55
    v_lshlrev_b32 v54, 16, v6
    v_and_b32 v55, 0xffff0000, v6
    v_mul_f32 v6, 0xbfb8aa3b, v56
    v_mul_f32 v7, 0xbfb8aa3b, v57
    v_exp_f32 v6, v6
    v_exp_f32 v7, v7
    v_add_f32 v6, 1.0, v6
    v_add_f32 v7, 1.0, v7
    v_rcp_f32 v6, v6
    v_rcp_f32 v7, v7
    v_mul_f32 v56, v56, v6
    v_mul_f32 v57, v57, v7
    v_cvt_pk_bf16_f32 v6, v56, v57
    v_lshlrev_b32 v56, 16, v6
    v_and_b32 v57, 0xffff0000, v6
    v_mul_f32 v6, 0xbfb8aa3b, v58
    v_mul_f32 v7, 0xbfb8aa3b, v59
    v_exp_f32 v6, v6
    v_exp_f32 v7, v7
    v_add_f32 v6, 1.0, v6
    v_add_f32 v7, 1.0, v7
    v_rcp_f32 v6, v6
    v_rcp_f32 v7, v7
    v_mul_f32 v58, v58, v6
    v_mul_f32 v59, v59, v7
    v_cvt_pk_bf16_f32 v6, v58, v59
    v_lshlrev_b32 v58, 16, v6
    v_and_b32 v59, 0xffff0000, v6
    v_mul_f32 v6, 0xbfb8aa3b, v60
    v_mul_f32 v7, 0xbfb8aa3b, v61
    v_exp_f32 v6, v6
    v_exp_f32 v7, v7
    v_add_f32 v6, 1.0, v6
    v_add_f32 v7, 1.0, v7
    v_rcp_f32 v6, v6
    v_rcp_f32 v7, v7
    v_mul_f32 v60, v60, v6
    v_mul_f32 v61, v61, v7
    v_cvt_pk_bf16_f32 v6, v60, v61
    v_lshlrev_b32 v60, 16, v6
    v_and_b32 v61, 0xffff0000, v6
    v_mul_f32 v6, 0xbfb8aa3b, v62
    v_mul_f32 v7, 0xbfb8aa3b, v63
    v_exp_f32 v6, v6
    v_exp_f32 v7, v7
    v_add_f32 v6, 1.0, v6
    v_add_f32 v7, 1.0, v7
    v_rcp_f32 v6, v6
    v_rcp_f32 v7, v7
    v_mul_f32 v62, v62, v6
    v_mul_f32 v63, v63, v7
    v_cvt_pk_bf16_f32 v6, v62, v63
    v_lshlrev_b32 v62, 16, v6
    v_and_b32 v63, 0xffff0000, v6
    s_cmp_eq_u32 s44, 1
    s_cbranch_scc1 L_own
    s_waitcnt vmcnt(4)
    s_barrier
    ds_read_b128 v[64:67], v24 offset:0
    ds_read_b128 v[72:75], v25 offset:0
    ds_read_b128 v[68:71], v24 offset:1024
    ds_read_b128 v[76:79], v25 offset:1024
    ds_read_b128 v[80:83], v24 offset:8192
    ds_read_b128 v[88:91], v25 offset:8192
    ds_read_b128 v[84:87], v24 offset:9216
    ds_read_b128 v[92:95], v25 offset:9216
    s_waitcnt lgkmcnt(6)
    v_mfma_f32_32x32x16_bf16 v[96:111], v[128:131], v[64:67], 0
    v_mfma_f32_32x32x16_bf16 v[112:127], v[128:131], v[72:75], 0
    s_add_u32 m0, s43, 49152
    s_add_u32 s47, s38, 6
    s_and_b32 s47, s47, 15
    s_lshl_b32 s47, s47, 12
    s_add_u32 s47, s47, s62
    buffer_load_dwordx4 v20, s[16:19], s47 offen sc1 lds
    s_waitcnt lgkmcnt(4)
    v_mfma_f32_32x32x16_bf16 v[96:111], v[132:135], v[68:71], v[96:111]
    v_mfma_f32_32x32x16_bf16 v[112:127], v[132:135], v[76:79], v[112:127]
    s_add_u32 m0, s43, 57344
    s_add_u32 s47, s38, 7
    s_and_b32 s47, s47, 15
    s_lshl_b32 s47, s47, 12
    s_add_u32 s47, s47, s62
    buffer_load_dwordx4 v20, s[16:19], s47 offen sc1 lds
    s_waitcnt vmcnt(4)
    s_barrier
    ds_read_b128 v[64:67], v24 offset:16384
    ds_read_b128 v[72:75], v25 offset:16384
    ds_read_b128 v[68:71], v24 offset:17408
    ds_read_b128 v[76:79], v25 offset:17408
    s_waitcnt lgkmcnt(6)
    v_mfma_f32_32x32x16_bf16 v[96:111], v[136:139], v[80:83], v[96:111]
    v_mfma_f32_32x32x16_bf16 v[112:127], v[136:139], v[88:91], v[112:127]
    s_add_u32 m0, s43, 65536
    s_add_u32 s47, s38, 8
    s_and_b32 s47, s47, 15
    s_lshl_b32 s47, s47, 12
    s_add_u32 s47, s47, s62
    buffer_load_dwordx4 v20, s[16:19], s47 offen sc1 lds
    s_waitcnt lgkmcnt(4)
    v_mfma_f32_32x32x16_bf16 v[96:111], v[140:143], v[84:87], v[96:111]
    v_mfma_f32_32x32x16_bf16 v[112:127], v[140:143], v[92:95], v[112:127]
    s_add_u32 m0, s43, 73728
    s_add_u32 s47, s38, 9
    s_and_b32 s47, s47, 15
    s_lshl_b32 s47, s47, 12
    s_add_u32 s47, s47, s62
    buffer_load_dwordx4 v20, s[16:19], s47 offen sc1 lds
    ds_read_b128 v[80:83], v24 offset:24576
    ds_read_b128 v[88:91], v25 offset:24576
    ds_read_b128 v[84:87], v24 offset:25600
    ds_read_b128 v[92:95], v25 offset:25600
    s_waitcnt lgkmcnt(6)
    v_mfma_f32_32x32x16_bf16 v[96:111], v[144:147], v[64:67], v[96:111]
    s_add_u32 m0, s43, 81920
    s_add_u32 s47, s38, 10
    s_and_b32 s47, s47, 15
    s_lshl_b32 s47, s47, 12
    s_add_u32 s47, s47, s62
    buffer_load_dwordx4 v20, s[16:19], s47 offen sc1 lds
    v_mfma_f32_32x32x16_bf16 v[112:127], v[144:147], v[72:75], v[112:127]
    s_add_u32 m0, s43, 90112
    s_add_u32 s47, s38, 11
    s_and_b32 s47, s47, 15
    s_lshl_b32 s47, s47, 12
    s_add_u32 s47, s47, s62
    buffer_load_dwordx4 v20, s[16:19], s47 offen sc1 lds
    s_waitcnt lgkmcnt(4)
    v_mfma_f32_32x32x16_bf16 v[96:111], v[148:151], v[68:71], v[96:111]
    s_waitcnt vmcnt(4)
    s_barrier
    v_mfma_f32_32x32x16_bf16 v[112:127], v[148:151], v[76:79], v[112:127]
    ds_read_b128 v[128:131], v24 offset:32768
    ds_read_b128 v[136:139], v25 offset:32768
    ds_read_b128 v[132:135], v24 offset:33792
    ds_read_b128 v[140:143], v25 offset:33792
    s_waitcnt lgkmcnt(6)
    v_mfma_f32_32x32x16_bf16 v[96:111], v[152:155], v[80:83], v[96:111]
    s_add_u32 m0, s43, 98304
    s_add_u32 s47, s38, 12
    s_and_b32 s47, s47, 15
    s_lshl_b32 s47, s47, 12
    s_add_u32 s47, s47, s62
    buffer_load_dwordx4 v20, s[16:19], s47 offen sc1 lds
    v_mfma_f32_32x32x16_bf16 v[112:127], v[152:155], v[88:91], v[112:127]
    s_add_u32 m0, s43, 106496
    s_add_u32 s47, s38, 13
    s_and_b32 s47, s47, 15
    s_lshl_b32 s47, s47, 12
    s_add_u32 s47, s47, s62
    buffer_load_dwordx4 v20, s[16:19], s47 offen sc1 lds
    s_waitcnt lgkmcnt(4)
    v_mfma_f32_32x32x16_bf16 v[96:111], v[156:159], v[84:87], v[96:111]
    ds_read_b128 v[64:67], v24 offset:40960
    ds_read_b128 v[72:75], v25 offset:40960
    v_mfma_f32_32x32x16_bf16 v[112:127], v[156:159], v[92:95], v[112:127]
    ds_read_b128 v[68:71], v24 offset:41984
    ds_read_b128 v[76:79], v25 offset:41984
    s_waitcnt lgkmcnt(6)
    v_mfma_f32_32x32x16_bf16 v[96:111], v[160:163], v[128:131], v[96:111]
    s_add_u32 m0, s43, 114688
    s_add_u32 s47, s38, 14
    s_and_b32 s47, s47, 15
    s_lshl_b32 s47, s47, 12
    s_add_u32 s47, s47, s62
    buffer_load_dwordx4 v20, s[16:19], s47 offen sc1 lds
    v_mfma_f32_32x32x16_bf16 v[112:127], v[160:163], v[136:139], v[112:127]
    s_add_u32 m0, s43, 122880
    s_add_u32 s47, s38, 15
    s_and_b32 s47, s47, 15
    s_lshl_b32 s47, s47, 12
    s_add_u32 s47, s47, s62
    buffer_load_dwordx4 v20, s[16:19], s47 offen sc1 lds
    s_waitcnt lgkmcnt(4)
    v_mfma_f32_32x32x16_bf16 v[96:111], v[164:167], v[132:135], v[96:111]
    ds_read_b128 v[80:83], v24 offset:49152
    ds_read_b128 v[88:91], v25 offset:49152
    v_mfma_f32_32x32x16_bf16 v[112:127], v[164:167], v[140:143], v[112:127]
    ds_read_b128 v[84:87], v24 offset:50176
    ds_read_b128 v[92:95], v25 offset:50176
    s_waitcnt lgkmcnt(6)
    v_mfma_f32_32x32x16_bf16 v[96:111], v[168:171], v[64:67], v[96:111]
    s_add_u32 m0, s43, 131072
    s_add_u32 s47, s38, 12
    s_and_b32 s47, s47, 15
    s_lshl_b32 s47, s47, 17
    s_add_u32 s47, s47, s53
    buffer_load_dwordx4 v19, s[8:11], s47 offen lds
    v_mfma_f32_32x32x16_bf16 v[112:127], v[168:171], v[72:75], v[112:127]
    s_add_u32 m0, s43, 139264
    s_add_u32 s47, s38, 12
    s_and_b32 s47, s47, 15
    s_lshl_b32 s47, s47, 17
    s_add_u32 s47, s47, s53
    s_add_u32 s47, s47, 32768
    buffer_load_dwordx4 v19, s[8:11], s47 offen lds
    s_waitcnt lgkmcnt(4)
    v_mfma_f32_32x32x16_bf16 v[96:111], v[172:175], v[68:71], v[96:111]
    ds_read_b128 v[128:131], v24 offset:57344
    ds_read_b128 v[136:139], v25 offset:57344
    v_mfma_f32_32x32x16_bf16 v[112:127], v[172:175], v[76:79], v[112:127]
    ds_read_b128 v[132:135], v24 offset:58368
    ds_read_b128 v[140:143], v25 offset:58368
    s_waitcnt lgkmcnt(6)
    v_mfma_f32_32x32x16_bf16 v[96:111], v[176:179], v[80:83], v[96:111]
    s_add_u32 m0, s43, 147456
    s_add_u32 s47, s38, 13
    s_and_b32 s47, s47, 15
    s_lshl_b32 s47, s47, 17
    s_add_u32 s47, s47, s53
    buffer_load_dwordx4 v19, s[8:11], s47 offen lds
    v_mfma_f32_32x32x16_bf16 v[112:127], v[176:179], v[88:91], v[112:127]
    s_add_u32 m0, s43, 155648
    s_add_u32 s47, s38, 13
    s_and_b32 s47, s47, 15
    s_lshl_b32 s47, s47, 17
    s_add_u32 s47, s47, s53
    s_add_u32 s47, s47, 32768
    buffer_load_dwordx4 v19, s[8:11], s47 offen lds
    s_waitcnt lgkmcnt(4)
    v_mfma_f32_32x32x16_bf16 v[96:111], v[180:183], v[84:87], v[96:111]
    s_waitcnt vmcnt(8)
    s_barrier
    v_mfma_f32_32x32x16_bf16 v[112:127], v[180:183], v[92:95], v[112:127]
    ds_read_b128 v[64:67], v26 offset:0
    ds_read_b128 v[72:75], v27 offset:0
    ds_read_b128 v[68:71], v26 offset:1024
    ds_read_b128 v[76:79], v27 offset:1024
    s_waitcnt lgkmcnt(6)
    v_mfma_f32_32x32x16_bf16 v[96:111], v[184:187], v[128:131], v[96:111]
    v_mfma_f32_32x32x16_bf16 v[112:127], v[184:187], v[136:139], v[112:127]
    s_waitcnt lgkmcnt(4)
    v_mfma_f32_32x32x16_bf16 v[96:111], v[188:191], v[132:135], v[96:111]
    ds_read_b128 v[80:83], v26 offset:8192
    ds_read_b128 v[88:91], v27 offset:8192
    v_mfma_f32_32x32x16_bf16 v[112:127], v[188:191], v[140:143], v[112:127]
    ds_read_b128 v[84:87], v26 offset:9216
    ds_read_b128 v[92:95], v27 offset:9216
    s_waitcnt lgkmcnt(6)
    v_mfma_f32_32x32x16_bf16 v[96:111], v[192:195], v[64:67], v[96:111]
    v_mfma_f32_32x32x16_bf16 v[112:127], v[192:195], v[72:75], v[112:127]
    ds_read_b128 v[128:131], v26 offset:16384
    ds_read_b128 v[136:139], v27 offset:16384
    ds_read_b128 v[132:135], v26 offset:17408
    ds_read_b128 v[140:143], v27 offset:17408
    s_waitcnt lgkmcnt(8)
    v_mfma_f32_32x32x16_bf16 v[96:111], v[196:199], v[68:71], v[96:111]
    s_waitcnt vmcnt(3)
    ds_read_b64_tr_b16 v[224:225], v1 offset:0
    ds_read_b64_tr_b16 v[226:227], v1 offset:512
    s_waitcnt vmcnt(2)
    ds_read_b64_tr_b16 v[228:229], v1 offset:8192
    ds_read_b64_tr_b16 v[230:231], v1 offset:8704
    v_mfma_f32_32x32x16_bf16 v[112:127], v[196:199], v[76:79], v[112:127]
    s_waitcnt vmcnt(1)
    ds_read_b64_tr_b16 v[232:233], v1 offset:16384
    ds_read_b64_tr_b16 v[234:235], v1 offset:16896
    s_waitcnt vmcnt(0)
    ds_read_b64_tr_b16 v[236:237], v1 offset:24576
    ds_read_b64_tr_b16 v[238:239], v1 offset:25088
    s_waitcnt lgkmcnt(6)
    s_waitcnt lgkmcnt(4)
    s_waitcnt lgkmcnt(2)
    s_waitcnt lgkmcnt(0)
    v_mfma_f32_32x32x16_bf16 v[96:111], v[200:203], v[80:83], v[96:111]
    s_add_u32 m0, s43, 131072
    s_add_u32 s47, s38, 14
    s_and_b32 s47, s47, 15
    s_lshl_b32 s47, s47, 17
    s_add_u32 s47, s47, s53
    buffer_load_dwordx4 v19, s[8:11], s47 offen lds
    v_mfma_f32_32x32x16_bf16 v[112:127], v[200:203], v[88:91], v[112:127]
    s_add_u32 m0, s43, 139264
    s_add_u32 s47, s38, 14
    s_and_b32 s47, s47, 15
    s_lshl_b32 s47, s47, 17
    s_add_u32 s47, s47, s53
    s_add_u32 s47, s47, 32768
    buffer_load_dwordx4 v19, s[8:11], s47 offen lds
    v_mfma_f32_32x32x16_bf16 v[96:111], v[204:207], v[84:87], v[96:111]
    ds_read_b128 v[64:67], v26 offset:24576
    ds_read_b128 v[72:75], v27 offset:24576
    v_mfma_f32_32x32x16_bf16 v[112:127], v[204:207], v[92:95], v[112:127]
    ds_read_b128 v[68:71], v26 offset:25600
    ds_read_b128 v[76:79], v27 offset:25600
    v_mfma_f32_32x32x16_bf16 v[96:111], v[208:211], v[128:131], v[96:111]
    s_add_u32 m0, s43, 147456
    s_add_u32 s47, s38, 15
    s_and_b32 s47, s47, 15
    s_lshl_b32 s47, s47, 17
    s_add_u32 s47, s47, s53
    buffer_load_dwordx4 v19, s[8:11], s47 offen lds
    v_mfma_f32_32x32x16_bf16 v[112:127], v[208:211], v[136:139], v[112:127]
    s_add_u32 m0, s43, 155648
    s_add_u32 s47, s38, 15
    s_and_b32 s47, s47, 15
    s_lshl_b32 s47, s47, 17
    s_add_u32 s47, s47, s53
    s_add_u32 s47, s47, 32768
    buffer_load_dwordx4 v19, s[8:11], s47 offen lds
    v_mfma_f32_32x32x16_bf16 v[96:111], v[212:215], v[132:135], v[96:111]
    s_barrier
    v_mfma_f32_32x32x16_bf16 v[112:127], v[212:215], v[140:143], v[112:127]
    ds_read_b128 v[80:83], v26 offset:32768
    ds_read_b128 v[88:91], v27 offset:32768
    ds_read_b128 v[84:87], v26 offset:33792
    ds_read_b128 v[92:95], v27 offset:33792
    s_waitcnt lgkmcnt(6)
    v_mfma_f32_32x32x16_bf16 v[96:111], v[216:219], v[64:67], v[96:111]
    v_mfma_f32_32x32x16_bf16 v[112:127], v[216:219], v[72:75], v[112:127]
    s_waitcnt lgkmcnt(4)
    v_mfma_f32_32x32x16_bf16 v[96:111], v[220:223], v[68:71], v[96:111]
    ds_read_b128 v[128:131], v26 offset:40960
    ds_read_b128 v[136:139], v27 offset:40960
    v_mfma_f32_32x32x16_bf16 v[112:127], v[220:223], v[76:79], v[112:127]
    ds_read_b128 v[132:135], v26 offset:41984
    ds_read_b128 v[140:143], v27 offset:41984
    s_waitcnt lgkmcnt(6)
    v_mfma_f32_32x32x16_bf16 v[96:111], v[224:227], v[80:83], v[96:111]
    v_mfma_f32_32x32x16_bf16 v[112:127], v[224:227], v[88:91], v[112:127]
    ds_read_b128 v[64:67], v26 offset:49152
    ds_read_b128 v[72:75], v27 offset:49152
    ds_read_b128 v[68:71], v26 offset:50176
    ds_read_b128 v[76:79], v27 offset:50176
    s_waitcnt lgkmcnt(8)
    v_mfma_f32_32x32x16_bf16 v[96:111], v[228:231], v[84:87], v[96:111]
    s_waitcnt vmcnt(3)
    ds_read_b64_tr_b16 v[240:241], v1 offset:0
    ds_read_b64_tr_b16 v[242:243], v1 offset:512
    s_waitcnt vmcnt(2)
    ds_read_b64_tr_b16 v[244:245], v1 offset:8192
    ds_read_b64_tr_b16 v[246:247], v1 offset:8704
    v_mfma_f32_32x32x16_bf16 v[112:127], v[228:231], v[92:95], v[112:127]
    s_waitcnt vmcnt(1)
    ds_read_b64_tr_b16 v[248:249], v1 offset:16384
    ds_read_b64_tr_b16 v[250:251], v1 offset:16896
    s_waitcnt vmcnt(0)
    ds_read_b64_tr_b16 v[252:253], v1 offset:24576
    ds_read_b64_tr_b16 v[254:255], v1 offset:25088
    s_waitcnt lgkmcnt(14)
    v_mfma_f32_32x32x16_bf16 v[96:111], v[232:235], v[128:131], v[96:111]
    v_mfma_f32_32x32x16_bf16 v[112:127], v[232:235], v[136:139], v[112:127]
    s_waitcnt lgkmcnt(12)
    v_mfma_f32_32x32x16_bf16 v[96:111], v[236:239], v[132:135], v[96:111]
    ds_read_b128 v[80:83], v26 offset:57344
    ds_read_b128 v[88:91], v27 offset:57344
    v_mfma_f32_32x32x16_bf16 v[112:127], v[236:239], v[140:143], v[112:127]
    ds_read_b128 v[84:87], v26 offset:58368
    ds_read_b128 v[92:95], v27 offset:58368
    s_waitcnt lgkmcnt(0)
    v_add_u32 v5, s43, v20
    v_mfma_f32_32x32x16_bf16 v[112:127], v[240:243], v[72:75], v[112:127]
    v_mfma_f32_32x32x16_bf16 v[112:127], v[244:247], v[76:79], v[112:127]
    v_mfma_f32_32x32x16_bf16 v[112:127], v[248:251], v[88:91], v[112:127]
    v_mfma_f32_32x32x16_bf16 v[112:127], v[252:255], v[92:95], v[112:127]
    v_add_u32 v5, 0x20000, v5
    v_xor_b32 v6, 0x400, v5
    v_mfma_f32_32x32x16_bf16 v[96:111], v[240:243], v[64:67], v[96:111]
    v_mfma_f32_32x32x16_bf16 v[96:111], v[244:247], v[68:71], v[96:111]
    v_mfma_f32_32x32x16_bf16 v[96:111], v[248:251], v[80:83], v[96:111]
    s_nop 6
    ds_write_b128 v5, v[112:115] offset:0
    ds_write_b128 v5, v[116:119] offset:8192
    ds_write_b128 v5, v[120:123] offset:16384
    ds_write_b128 v5, v[124:127] offset:24576
    v_mfma_f32_32x32x16_bf16 v[96:111], v[252:255], v[84:87], v[96:111]
    s_waitcnt lgkmcnt(0)
    s_barrier
    ds_read_b128 v[144:147], v6 offset:0
    ds_read_b128 v[148:151], v6 offset:8192
    ds_read_b128 v[152:155], v6 offset:16384
    ds_read_b128 v[156:159], v6 offset:24576
    s_waitcnt lgkmcnt(3)
    s_nop 4
    v_pk_add_f32 v[96:97], v[96:97], v[144:145]
    v_pk_add_f32 v[98:99], v[98:99], v[146:147]
    v_pk_fma_f32 v[96:97], v[96:97], v[48:49], v[32:33]
    v_pk_fma_f32 v[98:99], v[98:99], v[50:51], v[34:35]
    v_cvt_pk_bf16_f32 v8, v96, v97
    v_cvt_pk_bf16_f32 v9, v98, v99
    s_waitcnt lgkmcnt(2)
    v_pk_add_f32 v[100:101], v[100:101], v[148:149]
    v_pk_add_f32 v[102:103], v[102:103], v[150:151]
    v_pk_fma_f32 v[100:101], v[100:101], v[52:53], v[36:37]
    v_pk_fma_f32 v[102:103], v[102:103], v[54:55], v[38:39]
    v_cvt_pk_bf16_f32 v10, v100, v101
    v_cvt_pk_bf16_f32 v11, v102, v103
    buffer_store_dwordx4 v[8:11], v16, s[24:27], s60 offen
    s_waitcnt lgkmcnt(1)
    v_pk_add_f32 v[104:105], v[104:105], v[152:153]
    v_pk_add_f32 v[106:107], v[106:107], v[154:155]
    v_pk_fma_f32 v[104:105], v[104:105], v[56:57], v[40:41]
    v_pk_fma_f32 v[106:107], v[106:107], v[58:59], v[42:43]
    v_cvt_pk_bf16_f32 v12, v104, v105
    v_cvt_pk_bf16_f32 v13, v106, v107
    s_waitcnt lgkmcnt(0)
    v_pk_add_f32 v[108:109], v[108:109], v[156:157]
    v_pk_add_f32 v[110:111], v[110:111], v[158:159]
    v_pk_fma_f32 v[108:109], v[108:109], v[60:61], v[44:45]
    v_pk_fma_f32 v[110:111], v[110:111], v[62:63], v[46:47]
    v_cvt_pk_bf16_f32 v14, v108, v109
    v_cvt_pk_bf16_f32 v15, v110, v111
    buffer_store_dwordx4 v[12:15], v16, s[24:27], s60 offen offset:16
    s_endpgm
L_own:
    s_waitcnt vmcnt(4)
    s_barrier
    ds_read_b128 v[64:67], v24 offset:0
    ds_read_b128 v[72:75], v25 offset:0
    ds_read_b128 v[68:71], v24 offset:1024
    ds_read_b128 v[76:79], v25 offset:1024
    ds_read_b128 v[80:83], v24 offset:8192
    ds_read_b128 v[88:91], v25 offset:8192
    ds_read_b128 v[84:87], v24 offset:9216
    ds_read_b128 v[92:95], v25 offset:9216
    s_waitcnt lgkmcnt(6)
    v_mfma_f32_32x32x16_bf16 v[96:111], v[128:131], v[64:67], 0
    v_mfma_f32_32x32x16_bf16 v[112:127], v[128:131], v[72:75], 0
    s_add_u32 m0, s43, 49152
    s_add_u32 s47, s38, 6
    s_and_b32 s47, s47, 15
    s_lshl_b32 s47, s47, 12
    s_add_u32 s47, s47, s62
    buffer_load_dwordx4 v20, s[16:19], s47 offen sc1 lds
    s_waitcnt lgkmcnt(4)
    v_mfma_f32_32x32x16_bf16 v[96:111], v[132:135], v[68:71], v[96:111]
    v_mfma_f32_32x32x16_bf16 v[112:127], v[132:135], v[76:79], v[112:127]
    s_add_u32 m0, s43, 57344
    s_add_u32 s47, s38, 7
    s_and_b32 s47, s47, 15
    s_lshl_b32 s47, s47, 12
    s_add_u32 s47, s47, s62
    buffer_load_dwordx4 v20, s[16:19], s47 offen sc1 lds
    v_lshlrev_b32 v28, 7, v3
    s_mov_b32 s42, 0x68000
    buffer_load_dword v29, v28, s[16:19], s42 offen sc1
    s_waitcnt vmcnt(5)
    s_barrier
    ds_read_b128 v[64:67], v24 offset:16384
    ds_read_b128 v[72:75], v25 offset:16384
    ds_read_b128 v[68:71], v24 offset:17408
    ds_read_b128 v[76:79], v25 offset:17408
    s_waitcnt lgkmcnt(6)
    v_mfma_f32_32x32x16_bf16 v[96:111], v[136:139], v[80:83], v[96:111]
    v_mfma_f32_32x32x16_bf16 v[112:127], v[136:139], v[88:91], v[112:127]
    s_add_u32 m0, s43, 65536
    s_add_u32 s47, s38, 8
    s_and_b32 s47, s47, 15
    s_lshl_b32 s47, s47, 12
    s_add_u32 s47, s47, s62
    buffer_load_dwordx4 v20, s[16:19], s47 offen sc1 lds
    s_waitcnt lgkmcnt(4)
    v_mfma_f32_32x32x16_bf16 v[96:111], v[140:143], v[84:87], v[96:111]
    v_mfma_f32_32x32x16_bf16 v[112:127], v[140:143], v[92:95], v[112:127]
    s_add_u32 m0, s43, 73728
    s_add_u32 s47, s38, 9
    s_and_b32 s47, s47, 15
    s_lshl_b32 s47, s47, 12
    s_add_u32 s47, s47, s62
    buffer_load_dwordx4 v20, s[16:19], s47 offen sc1 lds
    ds_read_b128 v[80:83], v24 offset:24576
    ds_read_b128 v[88:91], v25 offset:24576
    ds_read_b128 v[84:87], v24 offset:25600
    ds_read_b128 v[92:95], v25 offset:25600
    s_waitcnt lgkmcnt(6)
    v_mfma_f32_32x32x16_bf16 v[96:111], v[144:147], v[64:67], v[96:111]
    s_add_u32 m0, s43, 81920
    s_add_u32 s47, s38, 10
    s_and_b32 s47, s47, 15
    s_lshl_b32 s47, s47, 12
    s_add_u32 s47, s47, s62
    buffer_load_dwordx4 v20, s[16:19], s47 offen sc1 lds
    v_mfma_f32_32x32x16_bf16 v[112:127], v[144:147], v[72:75], v[112:127]
    s_add_u32 m0, s43, 90112
    s_add_u32 s47, s38, 11
    s_and_b32 s47, s47, 15
    s_lshl_b32 s47, s47, 12
    s_add_u32 s47, s47, s62
    buffer_load_dwordx4 v20, s[16:19], s47 offen sc1 lds
    s_waitcnt lgkmcnt(4)
    v_mfma_f32_32x32x16_bf16 v[96:111], v[148:151], v[68:71], v[96:111]
    s_waitcnt vmcnt(5)
    s_barrier
    v_mfma_f32_32x32x16_bf16 v[112:127], v[148:151], v[76:79], v[112:127]
    ds_read_b128 v[128:131], v24 offset:32768
    ds_read_b128 v[136:139], v25 offset:32768
    ds_read_b128 v[132:135], v24 offset:33792
    ds_read_b128 v[140:143], v25 offset:33792
    s_waitcnt lgkmcnt(6)
    v_mfma_f32_32x32x16_bf16 v[96:111], v[152:155], v[80:83], v[96:111]
    s_add_u32 m0, s43, 98304
    s_add_u32 s47, s38, 12
    s_and_b32 s47, s47, 15
    s_lshl_b32 s47, s47, 12
    s_add_u32 s47, s47, s62
    buffer_load_dwordx4 v20, s[16:19], s47 offen sc1 lds
    v_mfma_f32_32x32x16_bf16 v[112:127], v[152:155], v[88:91], v[112:127]
    s_add_u32 m0, s43, 106496
    s_add_u32 s47, s38, 13
    s_and_b32 s47, s47, 15
    s_lshl_b32 s47, s47, 12
    s_add_u32 s47, s47, s62
    buffer_load_dwordx4 v20, s[16:19], s47 offen sc1 lds
    s_waitcnt lgkmcnt(4)
    v_mfma_f32_32x32x16_bf16 v[96:111], v[156:159], v[84:87], v[96:111]
    ds_read_b128 v[64:67], v24 offset:40960
    ds_read_b128 v[72:75], v25 offset:40960
    v_mfma_f32_32x32x16_bf16 v[112:127], v[156:159], v[92:95], v[112:127]
    ds_read_b128 v[68:71], v24 offset:41984
    ds_read_b128 v[76:79], v25 offset:41984
    s_waitcnt lgkmcnt(6)
    v_mfma_f32_32x32x16_bf16 v[96:111], v[160:163], v[128:131], v[96:111]
    s_add_u32 m0, s43, 114688
    s_add_u32 s47, s38, 14
    s_and_b32 s47, s47, 15
    s_lshl_b32 s47, s47, 12
    s_add_u32 s47, s47, s62
    buffer_load_dwordx4 v20, s[16:19], s47 offen sc1 lds
    v_mfma_f32_32x32x16_bf16 v[112:127], v[160:163], v[136:139], v[112:127]
    s_add_u32 m0, s43, 122880
    s_add_u32 s47, s38, 15
    s_and_b32 s47, s47, 15
    s_lshl_b32 s47, s47, 12
    s_add_u32 s47, s47, s62
    buffer_load_dwordx4 v20, s[16:19], s47 offen sc1 lds
    s_waitcnt vmcnt(8)
    s_mov_b32 s61, 0
    s_branch pchk_64
poll_63:
    buffer_load_dword v29, v28, s[16:19], s42 offen sc1
    s_waitcnt vmcnt(0)
pchk_64:
    v_cmp_ne_u32 vcc, 64, v29
    s_add_u32 s61, s61, 1
    s_cbranch_vccz pdone_65
    s_sleep 2
    s_cmp_lt_u32 s61, 200000
    s_cbranch_scc1 poll_63
pdone_65:
    s_waitcnt lgkmcnt(4)
    v_mfma_f32_32x32x16_bf16 v[96:111], v[164:167], v[132:135], v[96:111]
    ds_read_b128 v[80:83], v24 offset:49152
    ds_read_b128 v[88:91], v25 offset:49152
    v_lshrrev_b32 v28, 3, v2
    v_lshlrev_b32 v28, 12, v28
    v_and_b32 v29, 7, v2
    v_lshl_add_u32 v28, v29, 4, v28
    s_lshl_b32 s39, s58, 9
    s_lshl_b32 s40, s50, 7
    s_add_u32 s39, s39, s40
    s_add_u32 s40, s39, 0x50000
    buffer_load_dwordx4 v[144:147], v28, s[16:19], s40 offen sc1
    v_mfma_f32_32x32x16_bf16 v[112:127], v[164:167], v[140:143], v[112:127]
    ds_read_b128 v[84:87], v24 offset:50176
    ds_read_b128 v[92:95], v25 offset:50176
    s_lshr_b32 s39, s39, 1
    s_lshl_b32 s40, s54, 11
    s_add_u32 s39, s39, s40
    v_lshlrev_b32 v29, 3, v29
    buffer_load_dwordx2 v[148:149], v29, s[4:7], s39 offen
    s_waitcnt lgkmcnt(6)
    v_mfma_f32_32x32x16_bf16 v[96:111], v[168:171], v[64:67], v[96:111]
    s_add_u32 m0, s43, 131072
    s_add_u32 s47, s38, 12
    s_and_b32 s47, s47, 15
    s_lshl_b32 s47, s47, 17
    s_add_u32 s47, s47, s53
    buffer_load_dwordx4 v19, s[8:11], s47 offen lds
    s_and_b32 s40, s55, 0xffff0000
    s_xor_b32 s41, s40, 0x80000000
    s_xor_b32 s39, s40, 0xffff0000
    s_bitcmp1_b32 s40, 31
    s_cselect_b32 s40, s41, s39
    v_mov_b32 v28, s40
    s_and_b32 s40, s54, 31
    v_readlane_b32 s39, v30, s40
    v_readlane_b32 s41, v31, s40
    s_nop 0
    v_mov_b32 v156, s39
    v_mov_b32 v157, s41
    v_mfma_f32_32x32x16_bf16 v[112:127], v[168:171], v[72:75], v[112:127]
    s_add_u32 m0, s43, 139264
    s_add_u32 s47, s38, 12
    s_and_b32 s47, s47, 15
    s_lshl_b32 s47, s47, 17
    s_add_u32 s47, s47, s53
    s_add_u32 s47, s47, 32768
    buffer_load_dwordx4 v19, s[8:11], s47 offen lds
    v_mul_f32 v28, 0xbfb8aa3b, v28
    v_exp_f32 v28, v28
    s_waitcnt lgkmcnt(4)
    v_mfma_f32_32x32x16_bf16 v[96:111], v[172:175], v[68:71], v[96:111]
    ds_read_b128 v[128:131], v24 offset:57344
    ds_read_b128 v[136:139], v25 offset:57344
    v_add_f32 v28, 1.0, v28
    v_rcp_f32 v28, v28
    v_mfma_f32_32x32x16_bf16 v[112:127], v[172:175], v[76:79], v[112:127]
    ds_read_b128 v[132:135], v24 offset:58368
    ds_read_b128 v[140:143], v25 offset:58368
    v_cvt_pk_bf16_f32 v28, v28, v28
    v_lshlrev_b32 v28, 16, v28
    s_waitcnt lgkmcnt(6)
    v_mfma_f32_32x32x16_bf16 v[96:111], v[176:179], v[80:83], v[96:111]
    s_add_u32 m0, s43, 147456
    s_add_u32 s47, s38, 13
    s_and_b32 s47, s47, 15
    s_lshl_b32 s47, s47, 17
    s_add_u32 s47, s47, s53
    buffer_load_dwordx4 v19, s[8:11], s47 offen lds
    v_mfma_f32_32x32x16_bf16 v[112:127], v[176:179], v[88:91], v[112:127]
    s_add_u32 m0, s43, 155648
    s_add_u32 s47, s38, 13
    s_and_b32 s47, s47, 15
    s_lshl_b32 s47, s47, 17
    s_add_u32 s47, s47, s53
    s_add_u32 s47, s47, 32768
    buffer_load_dwordx4 v19, s[8:11], s47 offen lds
    s_waitcnt lgkmcnt(4)
    v_mfma_f32_32x32x16_bf16 v[96:111], v[180:183], v[84:87], v[96:111]
    s_waitcnt vmcnt(10)
    s_barrier
    v_mfma_f32_32x32x16_bf16 v[112:127], v[180:183], v[92:95], v[112:127]
    ds_read_b128 v[64:67], v26 offset:0
    ds_read_b128 v[72:75], v27 offset:0
    ds_read_b128 v[68:71], v26 offset:1024
    ds_read_b128 v[76:79], v27 offset:1024
    s_waitcnt lgkmcnt(6)
    v_mfma_f32_32x32x16_bf16 v[96:111], v[184:187], v[128:131], v[96:111]
    s_waitcnt vmcnt(4)
    v_add_f32_dpp v144, v144, v144 row_ror:8 row_mask:0xf bank_mask:0xf
    v_add_f32_dpp v145, v145, v145 row_ror:8 row_mask:0xf bank_mask:0xf
    v_add_f32_dpp v146, v146, v146 row_ror:8 row_mask:0xf bank_mask:0xf
    v_add_f32_dpp v147, v147, v147 row_ror:8 row_mask:0xf bank_mask:0xf
    v_mfma_f32_32x32x16_bf16 v[112:127], v[184:187], v[136:139], v[112:127]
    v_mov_b32 v164, v144
    v_mov_b32 v165, v145
    v_mov_b32 v166, v146
    v_mov_b32 v167, v147
    v_permlane16_swap_b32 v144, v164
    v_permlane16_swap_b32 v145, v165
    s_waitcnt lgkmcnt(4)
    v_mfma_f32_32x32x16_bf16 v[96:111], v[188:191], v[132:135], v[96:111]
    ds_read_b128 v[80:83], v26 offset:8192
    ds_read_b128 v[88:91], v27 offset:8192
    v_permlane16_swap_b32 v146, v166
    v_permlane16_swap_b32 v147, v167
    v_add_f32 v144, v144, v164
    v_add_f32 v145, v145, v165
    v_add_f32 v146, v146, v166
    v_mfma_f32_32x32x16_bf16 v[112:127], v[188:191], v[140:143], v[112:127]
    ds_read_b128 v[84:87], v26 offset:9216
    ds_read_b128 v[92:95], v27 offset:9216
    v_add_f32 v147, v147, v167
    v_mov_b32 v164, v144
    v_mov_b32 v165, v145
    v_mov_b32 v166, v146
    v_mov_b32 v167, v147
    v_permlane32_swap_b32 v144, v164
    s_waitcnt lgkmcnt(6)
    v_mfma_f32_32x32x16_bf16 v[96:111], v[192:195], v[64:67], v[96:111]
    v_permlane32_swap_b32 v145, v165
    v_permlane32_swap_b32 v146, v166
    v_permlane32_swap_b32 v147, v167
    v_add_f32 v144, v144, v164
    v_add_f32 v145, v145, v165
    v_mfma_f32_32x32x16_bf16 v[112:127], v[192:195], v[72:75], v[112:127]
    ds_read_b128 v[128:131], v26 offset:16384
    ds_read_b128 v[136:139], v27 offset:16384
    ds_read_b128 v[132:135], v26 offset:17408
    ds_read_b128 v[140:143], v27 offset:17408
    v_add_f32 v146, v146, v166
    v_add_f32 v147, v147, v167
    v_cvt_pk_bf16_f32 v162, v144, v145
    v_lshlrev_b32 v144, 16, v162
    v_and_b32 v145, 0xffff0000, v162
    s_waitcnt lgkmcnt(8)
    v_mfma_f32_32x32x16_bf16 v[96:111], v[196:199], v[68:71], v[96:111]
    s_waitcnt vmcnt(3)
    ds_read_b64_tr_b16 v[224:225], v1 offset:0
    ds_read_b64_tr_b16 v[226:227], v1 offset:512
    s_waitcnt vmcnt(2)
    ds_read_b64_tr_b16 v[228:229], v1 offset:8192
    ds_read_b64_tr_b16 v[230:231], v1 offset:8704
    v_mul_f32 v144, v144, v28
    v_mul_f32 v145, v145, v28
    v_cvt_pk_bf16_f32 v162, v144, v145
    v_lshlrev_b32 v144, 16, v162
    v_and_b32 v145, 0xffff0000, v162
    v_mfma_f32_32x32x16_bf16 v[112:127], v[196:199], v[76:79], v[112:127]
    s_waitcnt vmcnt(1)
    ds_read_b64_tr_b16 v[232:233], v1 offset:16384
    ds_read_b64_tr_b16 v[234:235], v1 offset:16896
    s_waitcnt vmcnt(0)
    ds_read_b64_tr_b16 v[236:237], v1 offset:24576
    ds_read_b64_tr_b16 v[238:239], v1 offset:25088
    v_cvt_pk_bf16_f32 v162, v146, v147
    v_lshlrev_b32 v146, 16, v162
    v_and_b32 v147, 0xffff0000, v162
    v_mul_f32 v146, v146, v28
    v_mul_f32 v147, v147, v28
    v_cvt_pk_bf16_f32 v162, v146, v147
    s_waitcnt lgkmcnt(6)
    s_waitcnt lgkmcnt(4)
    s_waitcnt lgkmcnt(2)
    s_waitcnt lgkmcnt(0)
    v_mfma_f32_32x32x16_bf16 v[96:111], v[200:203], v[80:83], v[96:111]
    s_add_u32 m0, s43, 131072
    s_add_u32 s47, s38, 14
    s_and_b32 s47, s47, 15
    s_lshl_b32 s47, s47, 17
    s_add_u32 s47, s47, s53
    buffer_load_dwordx4 v19, s[8:11], s47 offen lds
    v_lshlrev_b32 v146, 16, v162
    v_and_b32 v147, 0xffff0000, v162
    v_lshlrev_b32 v160, 16, v148
    v_and_b32 v161, 0xffff0000, v148
    v_sub_f32 v152, v160, v156
    v_mfma_f32_32x32x16_bf16 v[112:127], v[200:203], v[88:91], v[112:127]
    s_add_u32 m0, s43, 139264
    s_add_u32 s47, s38, 14
    s_and_b32 s47, s47, 15
    s_lshl_b32 s47, s47, 17
    s_add_u32 s47, s47, s53
    s_add_u32 s47, s47, 32768
    buffer_load_dwordx4 v19, s[8:11], s47 offen lds
    v_sub_f32 v153, v161, v156
    v_cvt_pk_bf16_f32 v162, v152, v153
    v_lshlrev_b32 v152, 16, v162
    v_and_b32 v153, 0xffff0000, v162
    v_mul_f32 v152, v152, v157
    v_mfma_f32_32x32x16_bf16 v[96:111], v[204:207], v[84:87], v[96:111]
    ds_read_b128 v[64:67], v26 offset:24576
    ds_read_b128 v[72:75], v27 offset:24576
    v_mul_f32 v153, v153, v157
    v_cvt_pk_bf16_f32 v162, v152, v153
    v_lshlrev_b32 v152, 16, v162
    v_and_b32 v153, 0xffff0000, v162
    v_lshlrev_b32 v160, 16, v149
    v_mfma_f32_32x32x16_bf16 v[112:127], v[204:207], v[92:95], v[112:127]
    ds_read_b128 v[68:71], v26 offset:25600
    ds_read_b128 v[76:79], v27 offset:25600
    v_and_b32 v161, 0xffff0000, v149
    v_sub_f32 v154, v160, v156
    v_sub_f32 v155, v161, v156
    v_cvt_pk_bf16_f32 v162, v154, v155
    v_lshlrev_b32 v154, 16, v162
    v_and_b32 v155, 0xffff0000, v162
    v_mfma_f32_32x32x16_bf16 v[96:111], v[208:211], v[128:131], v[96:111]
    s_add_u32 m0, s43, 147456
    s_add_u32 s47, s38, 15
    s_and_b32 s47, s47, 15
    s_lshl_b32 s47, s47, 17
    s_add_u32 s47, s47, s53
    buffer_load_dwordx4 v19, s[8:11], s47 offen lds
    v_mul_f32 v154, v154, v157
    v_mul_f32 v155, v155, v157
    v_cvt_pk_bf16_f32 v162, v154, v155
    v_lshlrev_b32 v154, 16, v162
    v_and_b32 v155, 0xffff0000, v162
    v_mfma_f32_32x32x16_bf16 v[112:127], v[208:211], v[136:139], v[112:127]
    s_add_u32 m0, s43, 155648
    s_add_u32 s47, s38, 15
    s_and_b32 s47, s47, 15
    s_lshl_b32 s47, s47, 17
    s_add_u32 s47, s47, s53
    s_add_u32 s47, s47, 32768
    buffer_load_dwordx4 v19, s[8:11], s47 offen lds
    v_add_f32 v152, v152, v144
    v_add_f32 v153, v153, v145
    v_cvt_pk_bf16_f32 v162, v152, v153
    v_lshlrev_b32 v152, 16, v162
    v_and_b32 v153, 0xffff0000, v162
    v_mfma_f32_32x32x16_bf16 v[96:111], v[212:215], v[132:135], v[96:111]
    s_barrier
    v_add_f32 v154, v154, v146
    v_add_f32 v155, v155, v147
    v_cvt_pk_bf16_f32 v162, v154, v155
    v_lshlrev_b32 v154, 16, v162
    v_and_b32 v155, 0xffff0000, v162
    v_mfma_f32_32x32x16_bf16 v[112:127], v[212:215], v[140:143], v[112:127]
    ds_read_b128 v[80:83], v26 offset:32768
    ds_read_b128 v[88:91], v27 offset:32768
    ds_read_b128 v[84:87], v26 offset:33792
    ds_read_b128 v[92:95], v27 offset:33792
    v_mul_f32 v162, 0xbfb8aa3b, v152
    v_mul_f32 v163, 0xbfb8aa3b, v153
    v_exp_f32 v162, v162
    v_exp_f32 v163, v163
    v_add_f32 v162, 1.0, v162
    v_add_f32 v163, 1.0, v163
    s_waitcnt lgkmcnt(6)
    v_mfma_f32_32x32x16_bf16 v[96:111], v[216:219], v[64:67], v[96:111]
    v_rcp_f32 v162, v162
    v_rcp_f32 v163, v163
    v_mul_f32 v152, v152, v162
    v_mul_f32 v153, v153, v163
    v_cvt_pk_bf16_f32 v162, v152, v153
    v_mfma_f32_32x32x16_bf16 v[112:127], v[216:219], v[72:75], v[112:127]
    v_lshlrev_b32 v152, 16, v162
    v_and_b32 v153, 0xffff0000, v162
    v_mul_f32 v162, 0xbfb8aa3b, v154
    v_mul_f32 v163, 0xbfb8aa3b, v155
    v_exp_f32 v162, v162
    s_waitcnt lgkmcnt(4)
    v_mfma_f32_32x32x16_bf16 v[96:111], v[220:223], v[68:71], v[96:111]
    ds_read_b128 v[128:131], v26 offset:40960
    ds_read_b128 v[136:139], v27 offset:40960
    v_exp_f32 v163, v163
    v_add_f32 v162, 1.0, v162
    v_add_f32 v163, 1.0, v163
    v_rcp_f32 v162, v162
    v_rcp_f32 v163, v163
    v_mfma_f32_32x32x16_bf16 v[112:127], v[220:223], v[76:79], v[112:127]
    ds_read_b128 v[132:135], v26 offset:41984
    ds_read_b128 v[140:143], v27 offset:41984
    v_mul_f32 v154, v154, v162
    v_mul_f32 v155, v155, v163
    v_cvt_pk_bf16_f32 v162, v154, v155
    v_lshlrev_b32 v154, 16, v162
    v_and_b32 v155, 0xffff0000, v162
    v_lshlrev_b32 v29, 4, v4
    s_waitcnt lgkmcnt(6)
    v_mfma_f32_32x32x16_bf16 v[96:111], v[224:227], v[80:83], v[96:111]
    ds_bpermute_b32 v160, v29, v152 offset:0
    ds_bpermute_b32 v161, v29, v153 offset:0
    ds_bpermute_b32 v162, v29, v154 offset:0
    ds_bpermute_b32 v163, v29, v155 offset:0
    v_mfma_f32_32x32x16_bf16 v[112:127], v[224:227], v[88:91], v[112:127]
    ds_read_b128 v[64:67], v26 offset:49152
    ds_read_b128 v[72:75], v27 offset:49152
    ds_read_b128 v[68:71], v26 offset:50176
    ds_read_b128 v[76:79], v27 offset:50176
    ds_bpermute_b32 v164, v29, v152 offset:4
    ds_bpermute_b32 v165, v29, v153 offset:4
    ds_bpermute_b32 v166, v29, v154 offset:4
    ds_bpermute_b32 v167, v29, v155 offset:4
    s_waitcnt lgkmcnt(15)
    v_mfma_f32_32x32x16_bf16 v[96:111], v[228:231], v[84:87], v[96:111]
    s_waitcnt vmcnt(3)
    ds_read_b64_tr_b16 v[240:241], v1 offset:0
    ds_read_b64_tr_b16 v[242:243], v1 offset:512
    s_waitcnt vmcnt(2)
    ds_read_b64_tr_b16 v[244:245], v1 offset:8192
    ds_read_b64_tr_b16 v[246:247], v1 offset:8704
    ds_bpermute_b32 v168, v29, v152 offset:8
    ds_bpermute_b32 v169, v29, v153 offset:8
    ds_bpermute_b32 v170, v29, v154 offset:8
    ds_bpermute_b32 v171, v29, v155 offset:8
    v_mfma_f32_32x32x16_bf16 v[112:127], v[228:231], v[92:95], v[112:127]
    s_waitcnt vmcnt(1)
    ds_read_b64_tr_b16 v[248:249], v1 offset:16384
    ds_read_b64_tr_b16 v[250:251], v1 offset:16896
    s_waitcnt vmcnt(0)
    ds_read_b64_tr_b16 v[252:253], v1 offset:24576
    ds_read_b64_tr_b16 v[254:255], v1 offset:25088
    ds_bpermute_b32 v172, v29, v152 offset:12
    ds_bpermute_b32 v173, v29, v153 offset:12
    ds_bpermute_b32 v174, v29, v154 offset:12
    ds_bpermute_b32 v175, v29, v155 offset:12
    s_waitcnt lgkmcnt(15)
    v_mfma_f32_32x32x16_bf16 v[96:111], v[232:235], v[128:131], v[96:111]
    s_waitcnt lgkmcnt(0)
    s_and_b32 s40, s54, 31
    v_cmp_eq_u32 vcc, s40, v3
    s_nop 1
    v_cndmask_b32 v48, v48, v160, vcc
    v_cndmask_b32 v49, v49, v161, vcc
    v_cndmask_b32 v50, v50, v162, vcc
    v_mfma_f32_32x32x16_bf16 v[112:127], v[232:235], v[136:139], v[112:127]
    v_cndmask_b32 v51, v51, v163, vcc
    v_cndmask_b32 v52, v52, v164, vcc
    v_cndmask_b32 v53, v53, v165, vcc
    v_cndmask_b32 v54, v54, v166, vcc
    v_mfma_f32_32x32x16_bf16 v[96:111], v[236:239], v[132:135], v[96:111]
    ds_read_b128 v[80:83], v26 offset:57344
    ds_read_b128 v[88:91], v27 offset:57344
    v_cndmask_b32 v55, v55, v167, vcc
    v_cndmask_b32 v56, v56, v168, vcc
    v_cndmask_b32 v57, v57, v169, vcc
    v_cndmask_b32 v58, v58, v170, vcc
    v_mfma_f32_32x32x16_bf16 v[112:127], v[236:239], v[140:143], v[112:127]
    ds_read_b128 v[84:87], v26 offset:58368
    ds_read_b128 v[92:95], v27 offset:58368
    v_cndmask_b32 v59, v59, v171, vcc
    v_cndmask_b32 v60, v60, v172, vcc
    v_cndmask_b32 v61, v61, v173, vcc
    v_cndmask_b32 v62, v62, v174, vcc
    v_cndmask_b32 v63, v63, v175, vcc
    s_waitcnt lgkmcnt(0)
    v_add_u32 v5, s43, v20
    v_mfma_f32_32x32x16_bf16 v[112:127], v[240:243], v[72:75], v[112:127]
    v_mfma_f32_32x32x16_bf16 v[112:127], v[244:247], v[76:79], v[112:127]
    v_mfma_f32_32x32x16_bf16 v[112:127], v[248:251], v[88:91], v[112:127]
    v_mfma_f32_32x32x16_bf16 v[112:127], v[252:255], v[92:95], v[112:127]
    v_add_u32 v5, 0x20000, v5
    v_xor_b32 v6, 0x400, v5
    v_mfma_f32_32x32x16_bf16 v[96:111], v[240:243], v[64:67], v[96:111]
    v_mfma_f32_32x32x16_bf16 v[96:111], v[244:247], v[68:71], v[96:111]
    v_mfma_f32_32x32x16_bf16 v[96:111], v[248:251], v[80:83], v[96:111]
    s_nop 6
    ds_write_b128 v5, v[112:115] offset:0
    ds_write_b128 v5, v[116:119] offset:8192
    ds_write_b128 v5, v[120:123] offset:16384
    ds_write_b128 v5, v[124:127] offset:24576
    v_mfma_f32_32x32x16_bf16 v[96:111], v[252:255], v[84:87], v[96:111]
    s_waitcnt lgkmcnt(0)
    s_barrier
    ds_read_b128 v[144:147], v6 offset:0
    ds_read_b128 v[148:151], v6 offset:8192
    ds_read_b128 v[152:155], v6 offset:16384
    ds_read_b128 v[156:159], v6 offset:24576
    s_waitcnt lgkmcnt(3)
    s_nop 4
    v_pk_add_f32 v[96:97], v[96:97], v[144:145]
    v_pk_add_f32 v[98:99], v[98:99], v[146:147]
    v_pk_fma_f32 v[96:97], v[96:97], v[48:49], v[32:33]
    v_pk_fma_f32 v[98:99], v[98:99], v[50:51], v[34:35]
    v_cvt_pk_bf16_f32 v8, v96, v97
    v_cvt_pk_bf16_f32 v9, v98, v99
    s_waitcnt lgkmcnt(2)
    v_pk_add_f32 v[100:101], v[100:101], v[148:149]
    v_pk_add_f32 v[102:103], v[102:103], v[150:151]
    v_pk_fma_f32 v[100:101], v[100:101], v[52:53], v[36:37]
    v_pk_fma_f32 v[102:103], v[102:103], v[54:55], v[38:39]
    v_cvt_pk_bf16_f32 v10, v100, v101
    v_cvt_pk_bf16_f32 v11, v102, v103
    buffer_store_dwordx4 v[8:11], v16, s[24:27], s60 offen
    s_waitcnt lgkmcnt(1)
    v_pk_add_f32 v[104:105], v[104:105], v[152:153]
    v_pk_add_f32 v[106:107], v[106:107], v[154:155]
    v_pk_fma_f32 v[104:105], v[104:105], v[56:57], v[40:41]
    v_pk_fma_f32 v[106:107], v[106:107], v[58:59], v[42:43]
    v_cvt_pk_bf16_f32 v12, v104, v105
    v_cvt_pk_bf16_f32 v13, v106, v107
    s_waitcnt lgkmcnt(0)
    v_pk_add_f32 v[108:109], v[108:109], v[156:157]
    v_pk_add_f32 v[110:111], v[110:111], v[158:159]
    v_pk_fma_f32 v[108:109], v[108:109], v[60:61], v[44:45]
    v_pk_fma_f32 v[110:111], v[110:111], v[62:63], v[46:47]
    v_cvt_pk_bf16_f32 v14, v108, v109
    v_cvt_pk_bf16_f32 v15, v110, v111
    buffer_store_dwordx4 v[12:15], v16, s[24:27], s60 offen offset:16
L_end:
    s_endpgm
L_fallback:
    s_nop 15
    v_mov_b32 v6, 0xff800000
    s_mov_b32 s39, 0
L_fb1:
    buffer_load_dwordx4 v[116:119], v20, s[20:23], s39 offen sc1
    buffer_load_dwordx4 v[120:123], v20, s[20:23], s39 offen offset:1024 sc1
    s_waitcnt vmcnt(0)
    v_mfma_f32_32x32x16_bf16 v[64:79], v[116:119], v[32:35], 0
    v_mfma_f32_32x32x16_bf16 v[64:79], v[120:123], v[36:39], v[64:79]
    s_nop 11
    v_max3_f32 v6, v6, v64, v65
    v_max3_f32 v6, v6, v66, v67
    v_max3_f32 v6, v6, v68, v69
    v_max3_f32 v6, v6, v70, v71
    v_max3_f32 v6, v6, v72, v73
    v_max3_f32 v6, v6, v74, v75
    v_max3_f32 v6, v6, v76, v77
    v_max3_f32 v6, v6, v78, v79
    s_add_u32 s39, s39, 4096
    s_cmp_lt_u32 s39, 0x40000
    s_cbranch_scc1 L_fb1
    v_mov_b32 v5, v6
    s_nop 1
    v_permlane32_swap_b32 v6, v5
    v_max_f32 v6, v6, v5
    v_sub_f32 v40, 0, v6
    v_sub_f32 v41, 0, v6
    v_sub_f32 v42, 0, v6
    v_sub_f32 v43, 0, v6
    v_sub_f32 v44, 0, v6
    v_sub_f32 v45, 0, v6
    v_sub_f32 v46, 0, v6
    v_sub_f32 v47, 0, v6
    v_sub_f32 v48, 0, v6
    v_sub_f32 v49, 0, v6
    v_sub_f32 v50, 0, v6
    v_sub_f32 v51, 0, v6
    v_sub_f32 v52, 0, v6
    v_sub_f32 v53, 0, v6
    v_sub_f32 v54, 0, v6
    v_sub_f32 v55, 0, v6
    v_mov_b32 v96, 0
    v_mov_b32 v97, 0
    v_mov_b32 v98, 0
    v_mov_b32 v99, 0
    v_mov_b32 v100, 0
    v_mov_b32 v101, 0
    v_mov_b32 v102, 0
    v_mov_b32 v103, 0
    v_mov_b32 v104, 0
    v_mov_b32 v105, 0
    v_mov_b32 v106, 0
    v_mov_b32 v107, 0
    v_mov_b32 v108, 0
    v_mov_b32 v109, 0
    v_mov_b32 v110, 0
    v_mov_b32 v111, 0
    v_mov_b32 v112, 0
    v_mov_b32 v113, 0
    v_mov_b32 v114, 0
    v_mov_b32 v115, 0
    s_mov_b32 s39, 0
L_fb2:
    buffer_load_dwordx4 v[116:119], v20, s[20:23], s39 offen sc1
    buffer_load_dwordx4 v[120:123], v20, s[20:23], s39 offen offset:1024 sc1
    buffer_load_dwordx4 v[56:59], v20, s[20:23], s39 offen offset:2048 sc1
    buffer_load_dwordx4 v[60:63], v20, s[20:23], s39 offen offset:3072 sc1
    s_waitcnt vmcnt(0)
    v_mfma_f32_32x32x16_bf16 v[64:79], v[116:119], v[32:35], v[40:55]
    v_mfma_f32_32x32x16_bf16 v[64:79], v[120:123], v[36:39], v[64:79]
    s_nop 11
    v_exp_f32 v64, v64
    v_exp_f32 v65, v65
    v_exp_f32 v66, v66
    v_exp_f32 v67, v67
    v_exp_f32 v68, v68
    v_exp_f32 v69, v69
    v_exp_f32 v70, v70
    v_exp_f32 v71, v71
    v_exp_f32 v72, v72
    v_exp_f32 v73, v73
    v_exp_f32 v74, v74
    v_exp_f32 v75, v75
    v_exp_f32 v76, v76
    v_exp_f32 v77, v77
    v_exp_f32 v78, v78
    v_exp_f32 v79, v79
    v_smfmac_f32_32x32x32_bf16 v[96:111], v[56:59], v[64:71], v29
    v_smfmac_f32_16x16x64_bf16 v[112:115], v[24:27], v[64:71], v29
    v_smfmac_f32_32x32x32_bf16 v[96:111], v[60:63], v[72:79], v29
    v_smfmac_f32_16x16x64_bf16 v[112:115], v[24:27], v[72:79], v29
    s_add_u32 s39, s39, 4096
    s_cmp_lt_u32 s39, 0x40000
    s_nop 7
    s_cbranch_scc1 L_fb2
    s_nop 15
    s_branch L_fin
L_code_end:
.section .rodata,"a"
.p2align 6
.amdhsa_kernel recurrent_scan__grouped_kv_mqa__moe_arch_mod__prompt_kernel
  .amdhsa_next_free_vgpr 256
  .amdhsa_next_free_sgpr 102
  .amdhsa_accum_offset 256
  .amdhsa_group_segment_fixed_size 0
  .amdhsa_kernarg_size 104
  .amdhsa_user_sgpr_count 2
  .amdhsa_user_sgpr_kernarg_segment_ptr 1
  .amdhsa_system_sgpr_workgroup_id_x 1
.end_amdhsa_kernel
```
